```python
import torch

def _softmax(x, axis=-1):
    return torch.softmax(x, dim=axis)
def _gelu(x):
    return torch.nn.functional.gelu(x, approximate="tanh")
def _silu(x):
    return torch.nn.functional.silu(x)
def _sigmoid(x):
    return torch.sigmoid(x)
def _layernorm(x, axis=-1, eps=1e-5):
    m = x.mean(dim=axis, keepdim=True)
    v = x.var(dim=axis, keepdim=True, unbiased=False)
    return (x - m) / torch.sqrt(v + eps)
def _scatter_add(tgt, idx, src, axis=0):
    return tgt.clone().index_add_(axis, idx, src)
def _segment_sum(src, seg, n):
    out = torch.zeros((n,) + src.shape[1:], dtype=src.dtype)
    return out.index_add_(0, seg, src)
def _pad(x, pw):
    flat = tuple(v for pair in reversed(pw) for v in pair)
    return torch.nn.functional.pad(x, flat)

kernel_name = 'gated_mix__softmax_full_mha__ssm_conv_h3__prompt'

def setup_inputs():

    _w = (lambda a: (lambda t: t.to(torch.bfloat16) if t.is_floating_point() else t)(torch.as_tensor(a)))
    def _A_setup():
        B, S, D = 1, 2048, 448
        return {
            "x": _w((lambda *s: torch.randn(*s, dtype=torch.bfloat16) * 0.05)(B, S, D)),
            "wqkv": _w((lambda *s: torch.randn(*s, dtype=torch.bfloat16) * 0.8)(D, 3 * D)),
            "wo": _w((lambda *s: torch.randn(*s, dtype=torch.bfloat16) * 0.05)(D, D)),
        }
    _A_in = _A_setup()

    def _B_setup():
        B, S, D = 1, 2048, 448
        ks = 4
        return {
            "q": _w((lambda *s: torch.randn(*s, dtype=torch.bfloat16) * 0.05)(B, S, D)),
            "k": _w((lambda *s: torch.randn(*s, dtype=torch.bfloat16) * 0.4)(B, S, D)),
            "v": _w((lambda *s: torch.randn(*s, dtype=torch.bfloat16) * 0.4)(B, S, D)),
            "shift_k": _w((lambda *s: torch.randn(*s, dtype=torch.bfloat16) * 0.4)(D, ks) * 0.5),
            "ssm_k": _w((lambda *s: torch.randn(*s, dtype=torch.bfloat16) * 0.8)(D, S) * (1.0 / S ** 0.5)),
            "ssm_D": _w((lambda *s: torch.randn(*s, dtype=torch.bfloat16) * 0.4)(D)),
        }
    _B_in = _B_setup()

    return {
        "A_x": _A_in["x"],
        "A_wqkv": _A_in["wqkv"],
        "A_wo": _A_in["wo"],
        "B_q": _B_in["q"],
        "B_k": _B_in["k"],
        "B_v": _B_in["v"],
        "B_shift_k": _B_in["shift_k"],
        "B_ssm_k": _B_in["ssm_k"],
        "B_ssm_D": _B_in["ssm_D"],
        "gate_w": _w((lambda *s: torch.randn(*s, dtype=torch.bfloat16) * 0.05)(448) * 16.0),
    }

def reference(A_x, A_wqkv, A_wo, B_q, B_k, B_v, B_shift_k, B_ssm_k, B_ssm_D, gate_w):
    def _A_ref(x, wqkv, wo):
        B, S, D = x.shape
        H = 16; Dh = D // H
        qkv = (lambda x, *d: x.permute(*d))((x @ wqkv).reshape(B, S, 3, H, Dh), 2, 0, 3, 1, 4)
        q, k, v = qkv[0], qkv[1], qkv[2]
        scale = Dh ** -0.5
        scores = torch.einsum("bhqd,bhkd->bhqk", q, k) * scale
        p = _softmax(scores, axis=-1)
        o = torch.einsum("bhqk,bhkd->bhqd", p, v)
        return (lambda x, *d: x.permute(*d))(o, 0, 2, 1, 3).reshape(B, S, D) @ wo

    def _B_ref(q, k, v, shift_k, ssm_k, ssm_D):
        B, S, D = q.shape
        ks = shift_k.shape[-1]
        k_pad = _pad(k, ((0, 0), (ks - 1, 0), (0, 0)))
        k_shift = torch.zeros_like(k)
        for t in range(ks):
            k_shift = k_shift + k_pad[:, t:t + S, :] * shift_k[:, ks - 1 - t][None, None, :]
        kv = k_shift * v
        L = 2 * S
        kv_pad = _pad(kv, ((0, 0), (0, S), (0, 0)))
        kf_pad = _pad(ssm_k, ((0, 0), (0, S)))
        kv_f = (lambda x, axes=(-2,-1): torch.fft.rfft2(x.float(), dim=axes))(kv_pad[:, None, :, :], axes=(1, 2))
        kf_f = (lambda x, axes=(-2,-1): torch.fft.rfft2(x.float(), dim=axes))(kf_pad[:, None, :], axes=(1, 2))
        kf_f = (lambda x, *d: x.permute(*d))(kf_f, 1, 2, 0)
        y_f = kv_f * kf_f[None, :, :, :]
        y = (lambda x, s, axes=(-2,-1): torch.fft.irfft2(x, s=s, dim=axes).to(torch.bfloat16))(y_f, (1, L), axes=(1, 2))[:, 0, :S, :]
        y = y + kv * ssm_D[None, None, :]
        return q * y

    x = A_x
    g = _sigmoid((x * gate_w).sum(-1, keepdims=True))
    a = _A_ref(x, A_wqkv, A_wo)
    b = _B_ref(x, B_k, B_v, B_shift_k, B_ssm_k, B_ssm_D)
    return g * a + (1 - g) * b
```

```asm
; @launch grid=(256,1,1) block=(512,1,1) lds=163840
.amdgcn_target "amdgcn-amd-amdhsa--gfx950"
.text
.globl gated_mix__softmax_full_mha__ssm_conv_h3__prompt_kernel
.p2align 8
.type gated_mix__softmax_full_mha__ssm_conv_h3__prompt_kernel,@function
gated_mix__softmax_full_mha__ssm_conv_h3__prompt_kernel:
    s_cmp_ge_u32 s2, 256
    s_cbranch_scc1 L_end_1
    s_load_dwordx2 s[16:17], s[0:1], 32
    s_load_dwordx2 s[20:21], s[0:1], 40
    s_load_dwordx2 s[8:9], s[0:1], 0
    s_load_dwordx2 s[12:13], s[0:1], 8
    v_lshrrev_b32 v2, 6, v0
    v_and_b32 v1, 63, v0
    v_readfirstlane_b32 s3, v2
    s_mov_b32 s18, 1835008
    s_mov_b32 s19, 0x20000
    s_mov_b32 s22, s18
    s_mov_b32 s23, 0x20000
    s_mov_b32 s10, s18
    s_mov_b32 s11, 0x20000
    s_mov_b32 s14, 1204224
    s_mov_b32 s15, 0x20000
    s_and_b32 s49, s2, 7
    s_lshr_b32 s48, s2, 3
    s_cmp_lt_u32 s48, 24
    s_cbranch_scc1 L_gwg_8
    s_sub_u32 s53, s48, 24
    s_lshl_b32 s67, s49, 3
    s_add_u32 s67, s67, s53
    s_mul_i32 s68, s67, 28672
    s_lshl_b32 s66, s3, 10
    s_add_u32 s68, s68, s66
    v_lshl_add_u32 v3, v1, 4, s68
    v_subrev_u32 v2, 2688, v3
    s_waitcnt lgkmcnt(0)
    s_add_u32 m0, s66, 0
    s_nop 0
    buffer_load_dwordx4 v2, s[16:19], 0 offen lds
    s_add_u32 m0, s66, 32768
    s_nop 0
    buffer_load_dwordx4 v3, s[20:23], 0 offen lds
    v_add_u32 v2, 8192, v2
    v_add_u32 v3, 8192, v3
    s_add_u32 m0, s66, 8192
    s_nop 0
    buffer_load_dwordx4 v2, s[16:19], 0 offen lds
    s_add_u32 m0, s66, 40960
    s_nop 0
    buffer_load_dwordx4 v3, s[20:23], 0 offen lds
    v_add_u32 v2, 8192, v2
    v_add_u32 v3, 8192, v3
    s_add_u32 m0, s66, 16384
    s_nop 0
    buffer_load_dwordx4 v2, s[16:19], 0 offen lds
    s_add_u32 m0, s66, 49152
    s_nop 0
    buffer_load_dwordx4 v3, s[20:23], 0 offen lds
    v_add_u32 v2, 8192, v2
    v_add_u32 v3, 8192, v3
    s_add_u32 m0, s66, 24576
    s_nop 0
    buffer_load_dwordx4 v2, s[16:19], 0 offen lds
    s_add_u32 m0, s66, 57344
    s_nop 0
    buffer_load_dwordx4 v3, s[20:23], 0 offen lds
    s_branch L_urest_10
L_gwg_8:
    s_cmp_ge_u32 s48, 5
    s_cbranch_scc1 L_nocpf_11
    s_getpc_b64 s[66:67]
L_here_12:
    s_sub_u32 s66, s66, L_here_12-gated_mix__softmax_full_mha__ssm_conv_h3__prompt_kernel
    s_subb_u32 s67, s67, 0
    s_lshl_b32 s68, s48, 3
    s_add_u32 s68, s68, s3
    s_lshl_b32 s68, s68, 10
    v_lshl_add_u32 v12, v1, 4, s68
    s_mov_b32 s68, L_code_end-gated_mix__softmax_full_mha__ssm_conv_h3__prompt_kernel-16
    v_min_u32 v10, s68, v12
    v_mov_b32 v11, s67
    v_add_co_u32 v10, vcc, s66, v10
    s_nop 1
    v_addc_co_u32 v11, vcc, 0, v11, vcc
    global_load_dwordx4 v[176:179], v[10:11], off
L_nocpf_11:
    s_cmp_lt_u32 s3, 4
    s_cbranch_scc1 L_roleA_9
    s_lshr_b32 s65, s49, 1
    s_lshl_b32 s65, s65, 2
    s_and_b32 s66, s48, 3
    s_add_u32 s64, s65, s66
    s_and_b32 s65, s49, 1
    s_mul_i32 s65, s65, 6
    s_lshr_b32 s66, s48, 2
    s_add_u32 s65, s65, s66
    s_lshr_b32 s62, s65, 2
    s_and_b32 s63, s65, 3
    s_sub_u32 s53, s3, 4
    s_lshl_b32 s65, s64, 7
    s_lshl_b32 s66, s53, 5
    s_add_u32 s65, s65, s66
    s_mul_i32 s65, s65, 896
    v_lshrrev_b32 v12, 3, v1
    v_mul_u32_u24 v12, 896, v12
    v_add_u32 v12, s65, v12
    v_and_b32 v13, 7, v1
    v_lshrrev_b32 v14, 4, v1
    v_xor_b32 v15, v13, v14
    v_lshl_add_u32 v2, v15, 4, v12
    v_xor_b32 v15, 4, v15
    v_lshl_add_u32 v3, v15, 4, v12
    v_add_u32 v3, 7168, v3
    v_add_u32 v4, 14336, v2
    v_add_u32 v5, 14336, v3
    s_mul_i32 s65, s53, 43008
    s_mul_i32 s66, s62, 896
    s_add_u32 s65, s65, s66
    s_mul_i32 s66, s63, 224
    s_add_u32 s65, s65, s66
    v_mul_u32_u24 v12, 2688, v14
    v_and_b32 v13, 15, v1
    v_lshlrev_b32 v15, 2, v14
    v_xor_b32 v13, v13, v15
    v_lshl_add_u32 v12, v13, 4, v12
    v_add_u32 v6, s65, v12
    s_lshl_b32 s71, s53, 12
    s_and_b32 s72, s48, 3
    s_lshl_b32 s72, s72, 1
    s_lshr_b32 s73, s48, 2
    s_add_u32 s72, s72, s73
    s_cmp_ge_u32 s72, 7
    s_cselect_b32 s73, 7, 0
    s_sub_u32 s72, s72, s73
    s_cmp_ge_u32 s72, 7
    s_cselect_b32 s73, 7, 0
    s_sub_u32 s72, s72, s73
    s_mov_b32 s73, 0
    s_waitcnt lgkmcnt(0)
    s_lshl_b32 s67, s72, 7
    s_mul_i32 s68, s72, 172032
    s_add_u32 s69, s71, s73
    s_add_u32 m0, s69, 0
    s_nop 0
    buffer_load_dwordx4 v2, s[8:11], s67 offen lds
    s_add_u32 m0, s69, 1024
    s_nop 0
    buffer_load_dwordx4 v3, s[8:11], s67 offen lds
    s_add_u32 m0, s69, 2048
    s_nop 0
    buffer_load_dwordx4 v4, s[8:11], s67 offen lds
    s_add_u32 m0, s69, 3072
    s_nop 0
    buffer_load_dwordx4 v5, s[8:11], s67 offen lds
    s_add_u32 m0, s69, 16384
    s_add_u32 s70, s68, 0
    buffer_load_dwordx4 v6, s[12:15], s70 offen lds
    s_add_u32 m0, s69, 17408
    s_add_u32 s70, s68, 10752
    buffer_load_dwordx4 v6, s[12:15], s70 offen lds
    s_add_u32 m0, s69, 18432
    s_add_u32 s70, s68, 21504
    buffer_load_dwordx4 v6, s[12:15], s70 offen lds
    s_add_u32 m0, s69, 19456
    s_add_u32 s70, s68, 32256
    buffer_load_dwordx4 v6, s[12:15], s70 offen lds
    s_add_u32 s72, s72, 1
    s_cmp_eq_u32 s72, 7
    s_cselect_b32 s72, 0, s72
    s_add_u32 s73, s73, 0x8000
    s_and_b32 s73, s73, 0x1ffff
    s_lshl_b32 s67, s72, 7
    s_mul_i32 s68, s72, 172032
    s_add_u32 s69, s71, s73
    s_add_u32 m0, s69, 0
    s_nop 0
    buffer_load_dwordx4 v2, s[8:11], s67 offen lds
    s_add_u32 m0, s69, 1024
    s_nop 0
    buffer_load_dwordx4 v3, s[8:11], s67 offen lds
    s_add_u32 m0, s69, 2048
    s_nop 0
    buffer_load_dwordx4 v4, s[8:11], s67 offen lds
    s_add_u32 m0, s69, 3072
    s_nop 0
    buffer_load_dwordx4 v5, s[8:11], s67 offen lds
    s_add_u32 m0, s69, 16384
    s_add_u32 s70, s68, 0
    buffer_load_dwordx4 v6, s[12:15], s70 offen lds
    s_add_u32 m0, s69, 17408
    s_add_u32 s70, s68, 10752
    buffer_load_dwordx4 v6, s[12:15], s70 offen lds
    s_add_u32 m0, s69, 18432
    s_add_u32 s70, s68, 21504
    buffer_load_dwordx4 v6, s[12:15], s70 offen lds
    s_add_u32 m0, s69, 19456
    s_add_u32 s70, s68, 32256
    buffer_load_dwordx4 v6, s[12:15], s70 offen lds
    s_add_u32 s72, s72, 1
    s_cmp_eq_u32 s72, 7
    s_cselect_b32 s72, 0, s72
    s_add_u32 s73, s73, 0x8000
    s_and_b32 s73, s73, 0x1ffff
    s_branch L_brest_13
L_roleA_9:
    s_load_dwordx2 s[24:25], s[0:1], 48
    s_load_dwordx2 s[4:5], s[0:1], 96
    s_load_dwordx2 s[44:45], s[0:1], 56
    s_load_dwordx2 s[28:29], s[0:1], 72
    s_load_dwordx2 s[32:33], s[0:1], 16
    s_load_dwordx2 s[36:37], s[0:1], 80
    s_load_dwordx2 s[40:41], s[0:1], 88
    s_load_dwordx2 s[46:47], s[0:1], 64
    s_mov_b32 s26, 3584
    s_mov_b32 s27, 0x20000
    s_mov_b32 s30, 896
    s_mov_b32 s31, 0x20000
    s_mov_b32 s6, 16777216
    s_mov_b32 s7, 0x20000
    s_mov_b32 s34, 401408
    s_mov_b32 s35, 0x20000
    s_mov_b32 s38, 1835008
    s_mov_b32 s39, 0x20000
    s_mov_b32 s42, 256
    s_mov_b32 s43, 0x20000
    s_and_b32 s50, s2, 15
    s_lshr_b32 s51, s2, 4
    s_lshr_b32 s65, s49, 1
    s_lshl_b32 s65, s65, 2
    s_and_b32 s66, s48, 3
    s_add_u32 s64, s65, s66
    s_and_b32 s65, s49, 1
    s_mul_i32 s65, s65, 6
    s_lshr_b32 s66, s48, 2
    s_add_u32 s65, s65, s66
    s_lshr_b32 s62, s65, 2
    s_and_b32 s63, s65, 3
    s_mul_i32 s65, s49, 24
    s_add_u32 s65, s65, s48
    s_lshl_b32 s65, s65, 1
    s_bfe_u32 s66, s3, 0x10001
    s_add_u32 s54, s65, s66
    s_mul_i32 s56, s66, 16640
    s_add_u32 s56, s56, 98304
    s_mul_i32 s57, s66, 4608
    s_add_u32 s57, s57, 131584
    s_lshl_b32 s58, s66, 13
    s_add_u32 s58, s58, 140800
    s_and_b32 s55, s3, 1
    s_cmp_lt_u32 s3, 4
    s_cselect_b32 s59, 1, 0
    s_lshl_b32 s65, s3, 12
    v_and_b32 v12, 31, v1
    v_lshrrev_b32 v13, 5, v1
    v_bfe_u32 v14, v1, 1, 3
    v_lshlrev_b32 v15, 7, v12
    v_add_u32 v15, s65, v15
    v_or_b32 v2, 0, v13
    v_xor_b32 v2, v2, v14
    v_lshl_add_u32 v2, v2, 4, v15
    v_or_b32 v3, 2, v13
    v_xor_b32 v3, v3, v14
    v_lshl_add_u32 v3, v3, 4, v15
    v_or_b32 v4, 4, v13
    v_xor_b32 v4, v4, v14
    v_lshl_add_u32 v4, v4, 4, v15
    v_or_b32 v5, 6, v13
    v_xor_b32 v5, v5, v14
    v_lshl_add_u32 v5, v5, 4, v15
    v_bfe_u32 v12, v1, 2, 2
    v_lshl_add_u32 v14, v13, 3, v12
    v_lshlrev_b32 v14, 8, v14
    v_bfe_u32 v15, v1, 4, 1
    v_lshlrev_b32 v15, 5, v15
    v_and_b32 v10, 3, v1
    v_lshl_add_u32 v15, v10, 3, v15
    v_lshlrev_b32 v12, 2, v12
    v_add_u32 v10, 0, v15
    v_lshrrev_b32 v11, 4, v10
    v_xor_b32 v11, v11, v12
    v_and_b32 v10, 8, v10
    v_lshl_add_u32 v11, v11, 4, v10
    v_add_u32 v6, v11, v14
    v_add_u32 v10, 56, v15
    v_lshrrev_b32 v11, 4, v10
    v_xor_b32 v11, v11, v12
    v_and_b32 v10, 8, v10
    v_lshl_add_u32 v11, v11, 4, v10
    v_add_u32 v7, v11, v14
    v_add_u32 v10, 112, v15
    v_lshrrev_b32 v11, 4, v10
    v_xor_b32 v11, v11, v12
    v_and_b32 v10, 8, v10
    v_lshl_add_u32 v11, v11, 4, v10
    v_add_u32 v8, v11, v14
    v_add_u32 v10, 168, v15
    v_lshrrev_b32 v11, 4, v10
    v_xor_b32 v11, v11, v12
    v_and_b32 v10, 8, v10
    v_lshl_add_u32 v11, v11, 4, v10
    v_add_u32 v9, v11, v14
    v_mov_b32 v16, 0
    v_mov_b32 v17, 0
    v_mov_b32 v18, 0
    v_mov_b32 v19, 0
    v_mov_b32 v20, 0
    v_mov_b32 v21, 0
    v_mov_b32 v22, 0
    v_mov_b32 v23, 0
    v_mov_b32 v24, 0
    v_mov_b32 v25, 0
    v_mov_b32 v26, 0
    v_mov_b32 v27, 0
    v_mov_b32 v28, 0
    v_mov_b32 v29, 0
    v_mov_b32 v30, 0
    v_mov_b32 v31, 0
    v_mov_b32 v32, 0
    v_mov_b32 v33, 0
    v_mov_b32 v34, 0
    v_mov_b32 v35, 0
    v_mov_b32 v36, 0
    v_mov_b32 v37, 0
    v_mov_b32 v38, 0
    v_mov_b32 v39, 0
    v_mov_b32 v40, 0
    v_mov_b32 v41, 0
    v_mov_b32 v42, 0
    v_mov_b32 v43, 0
    v_mov_b32 v44, 0
    v_mov_b32 v45, 0
    v_mov_b32 v46, 0
    v_mov_b32 v47, 0
    v_mov_b32 v48, 0
    v_mov_b32 v49, 0
    v_mov_b32 v50, 0
    v_mov_b32 v51, 0
    v_mov_b32 v52, 0
    v_mov_b32 v53, 0
    v_mov_b32 v54, 0
    v_mov_b32 v55, 0
    v_mov_b32 v56, 0
    v_mov_b32 v57, 0
    v_mov_b32 v58, 0
    v_mov_b32 v59, 0
    v_mov_b32 v60, 0
    v_mov_b32 v61, 0
    v_mov_b32 v62, 0
    v_mov_b32 v63, 0
    v_mov_b32 v64, 0
    v_mov_b32 v65, 0
    v_mov_b32 v66, 0
    v_mov_b32 v67, 0
    v_mov_b32 v68, 0
    v_mov_b32 v69, 0
    v_mov_b32 v70, 0
    v_mov_b32 v71, 0
    v_mov_b32 v72, 0
    v_mov_b32 v73, 0
    v_mov_b32 v74, 0
    v_mov_b32 v75, 0
    v_mov_b32 v76, 0
    v_mov_b32 v77, 0
    v_mov_b32 v78, 0
    v_mov_b32 v79, 0
    s_waitcnt lgkmcnt(0)
    s_lshr_b32 s65, s54, 1
    s_lshl_b32 s65, s65, 2
    s_load_dword s52, s[46:47], s65
    s_cmp_lg_u32 s2, 0
    s_cbranch_scc1 L_noinit_14
    v_lshlrev_b32 v10, 4, v1
    v_add_u32 v10, 6553600, v10
    s_mul_i32 s65, s3, 17408
    s_add_u32 s66, s65, 17408
L_zero_15:
    buffer_store_dwordx4 v[16:19], v10, s[4:7], s65 offen sc1
    s_add_u32 s65, s65, 1024
    s_cmp_lt_u32 s65, s66
    s_cbranch_scc1 L_zero_15
    s_waitcnt vmcnt(0)
    v_mov_b32 v10, s3
    v_mov_b32 v11, 1
    s_mov_b64 exec, 1
    buffer_store_byte v11, v10, s[40:43], 0 offen sc1
    s_mov_b64 exec, -1
L_noinit_14:
    s_barrier
    ds_read_b128 v[80:83], v2
    ds_read_b64_tr_b16 v[84:85], v6 offset:16384
    ds_read_b64_tr_b16 v[86:87], v6 offset:17408
    ds_read_b64_tr_b16 v[88:89], v7 offset:16384
    ds_read_b64_tr_b16 v[90:91], v7 offset:17408
    ds_read_b64_tr_b16 v[92:93], v8 offset:16384
    ds_read_b64_tr_b16 v[94:95], v8 offset:17408
    ds_read_b64_tr_b16 v[96:97], v9 offset:16384
    ds_read_b64_tr_b16 v[98:99], v9 offset:17408
    ds_read_b128 v[100:103], v3
    ds_read_b64_tr_b16 v[104:105], v6 offset:20480
    ds_read_b64_tr_b16 v[106:107], v6 offset:21504
    ds_read_b64_tr_b16 v[108:109], v7 offset:20480
    ds_read_b64_tr_b16 v[110:111], v7 offset:21504
    ds_read_b64_tr_b16 v[112:113], v8 offset:20480
    ds_read_b64_tr_b16 v[114:115], v8 offset:21504
    ds_read_b64_tr_b16 v[116:117], v9 offset:20480
    ds_read_b64_tr_b16 v[118:119], v9 offset:21504
    s_cmp_eq_u32 s62, 2
    s_cbranch_scc1 L_gemmV_16
    s_mov_b32 s70, 7
L_gemm_18:
    s_waitcnt lgkmcnt(9)
    v_mfma_f32_32x32x16_bf16 v[16:31], v[84:87], v[80:83], v[16:31]
    ds_read_b128 v[120:123], v4
    ds_read_b64_tr_b16 v[124:125], v6 offset:24576
    ds_read_b64_tr_b16 v[126:127], v6 offset:25600
    v_mfma_f32_32x32x16_bf16 v[32:47], v[88:91], v[80:83], v[32:47]
    ds_read_b64_tr_b16 v[128:129], v7 offset:24576
    ds_read_b64_tr_b16 v[130:131], v7 offset:25600
    ds_read_b64_tr_b16 v[132:133], v8 offset:24576
    v_mfma_f32_32x32x16_bf16 v[48:63], v[92:95], v[80:83], v[48:63]
    ds_read_b64_tr_b16 v[134:135], v8 offset:25600
    ds_read_b64_tr_b16 v[136:137], v9 offset:24576
    ds_read_b64_tr_b16 v[138:139], v9 offset:25600
    v_mfma_f32_32x32x16_bf16 v[64:79], v[96:99], v[80:83], v[64:79]
    s_waitcnt lgkmcnt(9)
    v_mfma_f32_32x32x16_bf16 v[16:31], v[104:107], v[100:103], v[16:31]
    ds_read_b128 v[140:143], v5
    ds_read_b64_tr_b16 v[144:145], v6 offset:28672
    ds_read_b64_tr_b16 v[146:147], v6 offset:29696
    v_mfma_f32_32x32x16_bf16 v[32:47], v[108:111], v[100:103], v[32:47]
    ds_read_b64_tr_b16 v[148:149], v7 offset:28672
    ds_read_b64_tr_b16 v[150:151], v7 offset:29696
    ds_read_b64_tr_b16 v[152:153], v8 offset:28672
    v_mfma_f32_32x32x16_bf16 v[48:63], v[112:115], v[100:103], v[48:63]
    ds_read_b64_tr_b16 v[154:155], v8 offset:29696
    ds_read_b64_tr_b16 v[156:157], v9 offset:28672
    ds_read_b64_tr_b16 v[158:159], v9 offset:29696
    v_mfma_f32_32x32x16_bf16 v[64:79], v[116:119], v[100:103], v[64:79]
    s_barrier
    s_waitcnt lgkmcnt(9)
    v_mfma_f32_32x32x16_bf16 v[16:31], v[124:127], v[120:123], v[16:31]
    v_add_u32 v2, 0x8000, v2
    v_and_b32 v2, 0x1ffff, v2
    ds_read_b128 v[80:83], v2
    v_add_u32 v6, 0x8000, v6
    v_and_b32 v6, 0x1ffff, v6
    v_mfma_f32_32x32x16_bf16 v[32:47], v[128:131], v[120:123], v[32:47]
    ds_read_b64_tr_b16 v[84:85], v6 offset:16384
    ds_read_b64_tr_b16 v[86:87], v6 offset:17408
    v_add_u32 v7, 0x8000, v7
    v_and_b32 v7, 0x1ffff, v7
    ds_read_b64_tr_b16 v[88:89], v7 offset:16384
    v_mfma_f32_32x32x16_bf16 v[48:63], v[132:135], v[120:123], v[48:63]
    ds_read_b64_tr_b16 v[90:91], v7 offset:17408
    v_add_u32 v8, 0x8000, v8
    v_and_b32 v8, 0x1ffff, v8
    ds_read_b64_tr_b16 v[92:93], v8 offset:16384
    ds_read_b64_tr_b16 v[94:95], v8 offset:17408
    v_mfma_f32_32x32x16_bf16 v[64:79], v[136:139], v[120:123], v[64:79]
    v_add_u32 v9, 0x8000, v9
    v_and_b32 v9, 0x1ffff, v9
    ds_read_b64_tr_b16 v[96:97], v9 offset:16384
    ds_read_b64_tr_b16 v[98:99], v9 offset:17408
    s_waitcnt lgkmcnt(9)
    v_mfma_f32_32x32x16_bf16 v[16:31], v[144:147], v[140:143], v[16:31]
    v_add_u32 v3, 0x8000, v3
    v_and_b32 v3, 0x1ffff, v3
    ds_read_b128 v[100:103], v3
    ds_read_b64_tr_b16 v[104:105], v6 offset:20480
    v_mfma_f32_32x32x16_bf16 v[32:47], v[148:151], v[140:143], v[32:47]
    ds_read_b64_tr_b16 v[106:107], v6 offset:21504
    ds_read_b64_tr_b16 v[108:109], v7 offset:20480
    ds_read_b64_tr_b16 v[110:111], v7 offset:21504
    ds_read_b64_tr_b16 v[112:113], v8 offset:20480
    v_mfma_f32_32x32x16_bf16 v[48:63], v[152:155], v[140:143], v[48:63]
    ds_read_b64_tr_b16 v[114:115], v8 offset:21504
    ds_read_b64_tr_b16 v[116:117], v9 offset:20480
    ds_read_b64_tr_b16 v[118:119], v9 offset:21504
    v_add_u32 v4, 0x8000, v4
    v_mfma_f32_32x32x16_bf16 v[64:79], v[156:159], v[140:143], v[64:79]
    v_and_b32 v4, 0x1ffff, v4
    v_add_u32 v5, 0x8000, v5
    v_and_b32 v5, 0x1ffff, v5
    s_sub_u32 s70, s70, 1
    s_cmp_lg_u32 s70, 0
    s_cbranch_scc1 L_gemm_18
    s_branch L_gemmE_17
L_gemmV_16:
    s_mov_b32 s70, 7
L_gemm_19:
    s_waitcnt lgkmcnt(9)
    v_mfma_f32_32x32x16_bf16 v[16:31], v[80:83], v[84:87], v[16:31]
    ds_read_b128 v[120:123], v4
    ds_read_b64_tr_b16 v[124:125], v6 offset:24576
    ds_read_b64_tr_b16 v[126:127], v6 offset:25600
    v_mfma_f32_32x32x16_bf16 v[32:47], v[80:83], v[88:91], v[32:47]
    ds_read_b64_tr_b16 v[128:129], v7 offset:24576
    ds_read_b64_tr_b16 v[130:131], v7 offset:25600
    ds_read_b64_tr_b16 v[132:133], v8 offset:24576
    v_mfma_f32_32x32x16_bf16 v[48:63], v[80:83], v[92:95], v[48:63]
    ds_read_b64_tr_b16 v[134:135], v8 offset:25600
    ds_read_b64_tr_b16 v[136:137], v9 offset:24576
    ds_read_b64_tr_b16 v[138:139], v9 offset:25600
    v_mfma_f32_32x32x16_bf16 v[64:79], v[80:83], v[96:99], v[64:79]
    s_waitcnt lgkmcnt(9)
    v_mfma_f32_32x32x16_bf16 v[16:31], v[100:103], v[104:107], v[16:31]
    ds_read_b128 v[140:143], v5
    ds_read_b64_tr_b16 v[144:145], v6 offset:28672
    ds_read_b64_tr_b16 v[146:147], v6 offset:29696
    v_mfma_f32_32x32x16_bf16 v[32:47], v[100:103], v[108:111], v[32:47]
    ds_read_b64_tr_b16 v[148:149], v7 offset:28672
    ds_read_b64_tr_b16 v[150:151], v7 offset:29696
    ds_read_b64_tr_b16 v[152:153], v8 offset:28672
    v_mfma_f32_32x32x16_bf16 v[48:63], v[100:103], v[112:115], v[48:63]
    ds_read_b64_tr_b16 v[154:155], v8 offset:29696
    ds_read_b64_tr_b16 v[156:157], v9 offset:28672
    ds_read_b64_tr_b16 v[158:159], v9 offset:29696
    v_mfma_f32_32x32x16_bf16 v[64:79], v[100:103], v[116:119], v[64:79]
    s_barrier
    s_waitcnt lgkmcnt(9)
    v_mfma_f32_32x32x16_bf16 v[16:31], v[120:123], v[124:127], v[16:31]
    v_add_u32 v2, 0x8000, v2
    v_and_b32 v2, 0x1ffff, v2
    ds_read_b128 v[80:83], v2
    v_add_u32 v6, 0x8000, v6
    v_and_b32 v6, 0x1ffff, v6
    v_mfma_f32_32x32x16_bf16 v[32:47], v[120:123], v[128:131], v[32:47]
    ds_read_b64_tr_b16 v[84:85], v6 offset:16384
    ds_read_b64_tr_b16 v[86:87], v6 offset:17408
    v_add_u32 v7, 0x8000, v7
    v_and_b32 v7, 0x1ffff, v7
    ds_read_b64_tr_b16 v[88:89], v7 offset:16384
    v_mfma_f32_32x32x16_bf16 v[48:63], v[120:123], v[132:135], v[48:63]
    ds_read_b64_tr_b16 v[90:91], v7 offset:17408
    v_add_u32 v8, 0x8000, v8
    v_and_b32 v8, 0x1ffff, v8
    ds_read_b64_tr_b16 v[92:93], v8 offset:16384
    ds_read_b64_tr_b16 v[94:95], v8 offset:17408
    v_mfma_f32_32x32x16_bf16 v[64:79], v[120:123], v[136:139], v[64:79]
    v_add_u32 v9, 0x8000, v9
    v_and_b32 v9, 0x1ffff, v9
    ds_read_b64_tr_b16 v[96:97], v9 offset:16384
    ds_read_b64_tr_b16 v[98:99], v9 offset:17408
    s_waitcnt lgkmcnt(9)
    v_mfma_f32_32x32x16_bf16 v[16:31], v[140:143], v[144:147], v[16:31]
    v_add_u32 v3, 0x8000, v3
    v_and_b32 v3, 0x1ffff, v3
    ds_read_b128 v[100:103], v3
    ds_read_b64_tr_b16 v[104:105], v6 offset:20480
    v_mfma_f32_32x32x16_bf16 v[32:47], v[140:143], v[148:151], v[32:47]
    ds_read_b64_tr_b16 v[106:107], v6 offset:21504
    ds_read_b64_tr_b16 v[108:109], v7 offset:20480
    ds_read_b64_tr_b16 v[110:111], v7 offset:21504
    ds_read_b64_tr_b16 v[112:113], v8 offset:20480
    v_mfma_f32_32x32x16_bf16 v[48:63], v[140:143], v[152:155], v[48:63]
    ds_read_b64_tr_b16 v[114:115], v8 offset:21504
    ds_read_b64_tr_b16 v[116:117], v9 offset:20480
    ds_read_b64_tr_b16 v[118:119], v9 offset:21504
    v_add_u32 v4, 0x8000, v4
    v_mfma_f32_32x32x16_bf16 v[64:79], v[140:143], v[156:159], v[64:79]
    v_and_b32 v4, 0x1ffff, v4
    v_add_u32 v5, 0x8000, v5
    v_and_b32 v5, 0x1ffff, v5
    s_sub_u32 s70, s70, 1
    s_cmp_lg_u32 s70, 0
    s_cbranch_scc1 L_gemm_19
L_gemmE_17:
    s_waitcnt lgkmcnt(0)
    v_mov_b32 v10, 0
    buffer_load_dword v11, v10, s[40:43], 0 offen sc1
    s_mov_b32 s66, 0
    s_mov_b32 s67, -1
    s_lshl_b32 s68, s63, 8
    s_lshl_b32 s69, s64, 2
    s_add_u32 s68, s68, s69
    s_add_u32 s68, s68, s3
    v_lshlrev_b32 v12, 4, v1
    s_cmp_eq_u32 s62, 1
    s_cbranch_scc1 L_epK_20
    s_cmp_eq_u32 s62, 2
    s_cbranch_scc1 L_epV_21
    s_lshl_b32 s69, s68, 11
    s_add_u32 s69, s69, 4194304
    v_add_u32 v13, s69, v12
    s_mov_b32 s70, 0x3e8b97f6
    v_mul_f32 v16, s70, v16
    v_mul_f32 v17, s70, v17
    v_mul_f32 v18, s70, v18
    v_mul_f32 v19, s70, v19
    v_mul_f32 v20, s70, v20
    v_mul_f32 v21, s70, v21
    v_mul_f32 v22, s70, v22
    v_mul_f32 v23, s70, v23
    v_mul_f32 v24, s70, v24
    v_mul_f32 v25, s70, v25
    v_mul_f32 v26, s70, v26
    v_mul_f32 v27, s70, v27
    v_mul_f32 v28, s70, v28
    v_mul_f32 v29, s70, v29
    v_mul_f32 v30, s70, v30
    v_mul_f32 v31, s70, v31
    v_cvt_pk_bf16_f32 v80, v16, v17
    v_cvt_pk_bf16_f32 v81, v18, v19
    v_cvt_pk_bf16_f32 v82, v20, v21
    v_cvt_pk_bf16_f32 v83, v22, v23
    v_cvt_pk_bf16_f32 v84, v24, v25
    v_cvt_pk_bf16_f32 v85, v26, v27
    v_cvt_pk_bf16_f32 v86, v28, v29
    v_cvt_pk_bf16_f32 v87, v30, v31
    v_cndmask_b32 v86, v86, 0, s[66:67]
    v_cndmask_b32 v87, v87, 0, s[66:67]
    s_mov_b32 s71, 0
    buffer_store_dwordx4 v[80:83], v13, s[4:7], s71 offen offset:0 sc1
    buffer_store_dwordx4 v[84:87], v13, s[4:7], s71 offen offset:1024 sc1
    v_mul_f32 v32, s70, v32
    v_mul_f32 v33, s70, v33
    v_mul_f32 v34, s70, v34
    v_mul_f32 v35, s70, v35
    v_mul_f32 v36, s70, v36
    v_mul_f32 v37, s70, v37
    v_mul_f32 v38, s70, v38
    v_mul_f32 v39, s70, v39
    v_mul_f32 v40, s70, v40
    v_mul_f32 v41, s70, v41
    v_mul_f32 v42, s70, v42
    v_mul_f32 v43, s70, v43
    v_mul_f32 v44, s70, v44
    v_mul_f32 v45, s70, v45
    v_mul_f32 v46, s70, v46
    v_mul_f32 v47, s70, v47
    v_cvt_pk_bf16_f32 v88, v32, v33
    v_cvt_pk_bf16_f32 v89, v34, v35
    v_cvt_pk_bf16_f32 v90, v36, v37
    v_cvt_pk_bf16_f32 v91, v38, v39
    v_cvt_pk_bf16_f32 v92, v40, v41
    v_cvt_pk_bf16_f32 v93, v42, v43
    v_cvt_pk_bf16_f32 v94, v44, v45
    v_cvt_pk_bf16_f32 v95, v46, v47
    v_cndmask_b32 v94, v94, 0, s[66:67]
    v_cndmask_b32 v95, v95, 0, s[66:67]
    s_mov_b32 s71, 131072
    buffer_store_dwordx4 v[88:91], v13, s[4:7], s71 offen offset:0 sc1
    buffer_store_dwordx4 v[92:95], v13, s[4:7], s71 offen offset:1024 sc1
    v_mul_f32 v48, s70, v48
    v_mul_f32 v49, s70, v49
    v_mul_f32 v50, s70, v50
    v_mul_f32 v51, s70, v51
    v_mul_f32 v52, s70, v52
    v_mul_f32 v53, s70, v53
    v_mul_f32 v54, s70, v54
    v_mul_f32 v55, s70, v55
    v_mul_f32 v56, s70, v56
    v_mul_f32 v57, s70, v57
    v_mul_f32 v58, s70, v58
    v_mul_f32 v59, s70, v59
    v_mul_f32 v60, s70, v60
    v_mul_f32 v61, s70, v61
    v_mul_f32 v62, s70, v62
    v_mul_f32 v63, s70, v63
    v_cvt_pk_bf16_f32 v96, v48, v49
    v_cvt_pk_bf16_f32 v97, v50, v51
    v_cvt_pk_bf16_f32 v98, v52, v53
    v_cvt_pk_bf16_f32 v99, v54, v55
    v_cvt_pk_bf16_f32 v100, v56, v57
    v_cvt_pk_bf16_f32 v101, v58, v59
    v_cvt_pk_bf16_f32 v102, v60, v61
    v_cvt_pk_bf16_f32 v103, v62, v63
    v_cndmask_b32 v102, v102, 0, s[66:67]
    v_cndmask_b32 v103, v103, 0, s[66:67]
    s_mov_b32 s71, 262144
    buffer_store_dwordx4 v[96:99], v13, s[4:7], s71 offen offset:0 sc1
    buffer_store_dwordx4 v[100:103], v13, s[4:7], s71 offen offset:1024 sc1
    v_mul_f32 v64, s70, v64
    v_mul_f32 v65, s70, v65
    v_mul_f32 v66, s70, v66
    v_mul_f32 v67, s70, v67
    v_mul_f32 v68, s70, v68
    v_mul_f32 v69, s70, v69
    v_mul_f32 v70, s70, v70
    v_mul_f32 v71, s70, v71
    v_mul_f32 v72, s70, v72
    v_mul_f32 v73, s70, v73
    v_mul_f32 v74, s70, v74
    v_mul_f32 v75, s70, v75
    v_mul_f32 v76, s70, v76
    v_mul_f32 v77, s70, v77
    v_mul_f32 v78, s70, v78
    v_mul_f32 v79, s70, v79
    v_cvt_pk_bf16_f32 v104, v64, v65
    v_cvt_pk_bf16_f32 v105, v66, v67
    v_cvt_pk_bf16_f32 v106, v68, v69
    v_cvt_pk_bf16_f32 v107, v70, v71
    v_cvt_pk_bf16_f32 v108, v72, v73
    v_cvt_pk_bf16_f32 v109, v74, v75
    v_cvt_pk_bf16_f32 v110, v76, v77
    v_cvt_pk_bf16_f32 v111, v78, v79
    v_cndmask_b32 v110, v110, 0, s[66:67]
    v_cndmask_b32 v111, v111, 0, s[66:67]
    s_mov_b32 s71, 393216
    buffer_store_dwordx4 v[104:107], v13, s[4:7], s71 offen offset:0 sc1
    buffer_store_dwordx4 v[108:111], v13, s[4:7], s71 offen offset:1024 sc1
    s_branch L_epD_22
L_epK_20:
    s_lshl_b32 s69, s68, 12
    s_add_u32 s69, s69, 0
    v_add_u32 v13, s69, v12
    v_mov_b32 v14, 0x3f803f80
    v_mov_b32 v15, 0x00003f80
    v_cndmask_b32 v28, v28, 0, s[66:67]
    v_cndmask_b32 v29, v29, 0, s[66:67]
    v_cndmask_b32 v30, v30, 0, s[66:67]
    v_cndmask_b32 v31, v31, 0, s[66:67]
    v_cvt_pk_bf16_f32 v80, v16, v17
    v_cvt_pk_bf16_f32 v81, v18, v19
    v_cvt_pk_bf16_f32 v82, v20, v21
    v_cvt_pk_bf16_f32 v83, v22, v23
    v_cvt_pk_bf16_f32 v84, v24, v25
    v_cvt_pk_bf16_f32 v85, v26, v27
    v_cvt_pk_bf16_f32 v86, v28, v29
    v_cvt_pk_bf16_f32 v87, v30, v31
    v_cndmask_b32 v86, v86, v14, s[66:67]
    v_cndmask_b32 v87, v87, v15, s[66:67]
    s_mov_b32 s71, 0
    buffer_store_dwordx4 v[80:83], v13, s[4:7], s71 offen offset:0 sc1
    buffer_store_dwordx4 v[84:87], v13, s[4:7], s71 offen offset:1024 sc1
    v_cndmask_b32 v44, v44, 0, s[66:67]
    v_cndmask_b32 v45, v45, 0, s[66:67]
    v_cndmask_b32 v46, v46, 0, s[66:67]
    v_cndmask_b32 v47, v47, 0, s[66:67]
    v_cvt_pk_bf16_f32 v88, v32, v33
    v_cvt_pk_bf16_f32 v89, v34, v35
    v_cvt_pk_bf16_f32 v90, v36, v37
    v_cvt_pk_bf16_f32 v91, v38, v39
    v_cvt_pk_bf16_f32 v92, v40, v41
    v_cvt_pk_bf16_f32 v93, v42, v43
    v_cvt_pk_bf16_f32 v94, v44, v45
    v_cvt_pk_bf16_f32 v95, v46, v47
    v_cndmask_b32 v94, v94, v14, s[66:67]
    v_cndmask_b32 v95, v95, v15, s[66:67]
    s_mov_b32 s71, 262144
    buffer_store_dwordx4 v[88:91], v13, s[4:7], s71 offen offset:0 sc1
    buffer_store_dwordx4 v[92:95], v13, s[4:7], s71 offen offset:1024 sc1
    v_cndmask_b32 v60, v60, 0, s[66:67]
    v_cndmask_b32 v61, v61, 0, s[66:67]
    v_cndmask_b32 v62, v62, 0, s[66:67]
    v_cndmask_b32 v63, v63, 0, s[66:67]
    v_cvt_pk_bf16_f32 v96, v48, v49
    v_cvt_pk_bf16_f32 v97, v50, v51
    v_cvt_pk_bf16_f32 v98, v52, v53
    v_cvt_pk_bf16_f32 v99, v54, v55
    v_cvt_pk_bf16_f32 v100, v56, v57
    v_cvt_pk_bf16_f32 v101, v58, v59
    v_cvt_pk_bf16_f32 v102, v60, v61
    v_cvt_pk_bf16_f32 v103, v62, v63
    v_cndmask_b32 v102, v102, v14, s[66:67]
    v_cndmask_b32 v103, v103, v15, s[66:67]
    s_mov_b32 s71, 524288
    buffer_store_dwordx4 v[96:99], v13, s[4:7], s71 offen offset:0 sc1
    buffer_store_dwordx4 v[100:103], v13, s[4:7], s71 offen offset:1024 sc1
    v_cndmask_b32 v76, v76, 0, s[66:67]
    v_cndmask_b32 v77, v77, 0, s[66:67]
    v_cndmask_b32 v78, v78, 0, s[66:67]
    v_cndmask_b32 v79, v79, 0, s[66:67]
    v_cvt_pk_bf16_f32 v104, v64, v65
    v_cvt_pk_bf16_f32 v105, v66, v67
    v_cvt_pk_bf16_f32 v106, v68, v69
    v_cvt_pk_bf16_f32 v107, v70, v71
    v_cvt_pk_bf16_f32 v108, v72, v73
    v_cvt_pk_bf16_f32 v109, v74, v75
    v_cvt_pk_bf16_f32 v110, v76, v77
    v_cvt_pk_bf16_f32 v111, v78, v79
    v_cndmask_b32 v110, v110, v14, s[66:67]
    v_cndmask_b32 v111, v111, v15, s[66:67]
    s_mov_b32 s71, 786432
    buffer_store_dwordx4 v[104:107], v13, s[4:7], s71 offen offset:0 sc1
    buffer_store_dwordx4 v[108:111], v13, s[4:7], s71 offen offset:1024 sc1
    v_mul_f32 v120, v16, v16
    v_mul_f32 v121, v32, v32
    v_mul_f32 v122, v48, v48
    v_mul_f32 v123, v64, v64
    v_fmac_f32 v120, v17, v17
    v_fmac_f32 v121, v33, v33
    v_fmac_f32 v122, v49, v49
    v_fmac_f32 v123, v65, v65
    v_fmac_f32 v120, v18, v18
    v_fmac_f32 v121, v34, v34
    v_fmac_f32 v122, v50, v50
    v_fmac_f32 v123, v66, v66
    v_fmac_f32 v120, v19, v19
    v_fmac_f32 v121, v35, v35
    v_fmac_f32 v122, v51, v51
    v_fmac_f32 v123, v67, v67
    v_fmac_f32 v120, v20, v20
    v_fmac_f32 v121, v36, v36
    v_fmac_f32 v122, v52, v52
    v_fmac_f32 v123, v68, v68
    v_fmac_f32 v120, v21, v21
    v_fmac_f32 v121, v37, v37
    v_fmac_f32 v122, v53, v53
    v_fmac_f32 v123, v69, v69
    v_fmac_f32 v120, v22, v22
    v_fmac_f32 v121, v38, v38
    v_fmac_f32 v122, v54, v54
    v_fmac_f32 v123, v70, v70
    v_fmac_f32 v120, v23, v23
    v_fmac_f32 v121, v39, v39
    v_fmac_f32 v122, v55, v55
    v_fmac_f32 v123, v71, v71
    v_fmac_f32 v120, v24, v24
    v_fmac_f32 v121, v40, v40
    v_fmac_f32 v122, v56, v56
    v_fmac_f32 v123, v72, v72
    v_fmac_f32 v120, v25, v25
    v_fmac_f32 v121, v41, v41
    v_fmac_f32 v122, v57, v57
    v_fmac_f32 v123, v73, v73
    v_fmac_f32 v120, v26, v26
    v_fmac_f32 v121, v42, v42
    v_fmac_f32 v122, v58, v58
    v_fmac_f32 v123, v74, v74
    v_fmac_f32 v120, v27, v27
    v_fmac_f32 v121, v43, v43
    v_fmac_f32 v122, v59, v59
    v_fmac_f32 v123, v75, v75
    v_fmac_f32 v120, v28, v28
    v_fmac_f32 v121, v44, v44
    v_fmac_f32 v122, v60, v60
    v_fmac_f32 v123, v76, v76
    v_fmac_f32 v120, v29, v29
    v_fmac_f32 v121, v45, v45
    v_fmac_f32 v122, v61, v61
    v_fmac_f32 v123, v77, v77
    v_fmac_f32 v120, v30, v30
    v_fmac_f32 v121, v46, v46
    v_fmac_f32 v122, v62, v62
    v_fmac_f32 v123, v78, v78
    v_fmac_f32 v120, v31, v31
    v_fmac_f32 v121, v47, v47
    v_fmac_f32 v122, v63, v63
    v_fmac_f32 v123, v79, v79
    v_mov_b32 v124, v120
    v_mov_b32 v125, v121
    v_mov_b32 v126, v122
    v_mov_b32 v127, v123
    v_permlane32_swap_b32 v120, v124
    v_permlane32_swap_b32 v121, v125
    v_permlane32_swap_b32 v122, v126
    v_permlane32_swap_b32 v123, v127
    v_add_f32 v120, v120, v124
    v_add_f32 v121, v121, v125
    v_add_f32 v122, v122, v126
    v_add_f32 v123, v123, v127
    v_max_f32_dpp v120, v120, v120 row_shr:1 row_mask:0xf bank_mask:0xf bound_ctrl:1
    v_max_f32_dpp v121, v121, v121 row_shr:1 row_mask:0xf bank_mask:0xf bound_ctrl:1
    v_max_f32_dpp v122, v122, v122 row_shr:1 row_mask:0xf bank_mask:0xf bound_ctrl:1
    v_max_f32_dpp v123, v123, v123 row_shr:1 row_mask:0xf bank_mask:0xf bound_ctrl:1
    v_max_f32_dpp v120, v120, v120 row_shr:2 row_mask:0xf bank_mask:0xf bound_ctrl:1
    v_max_f32_dpp v121, v121, v121 row_shr:2 row_mask:0xf bank_mask:0xf bound_ctrl:1
    v_max_f32_dpp v122, v122, v122 row_shr:2 row_mask:0xf bank_mask:0xf bound_ctrl:1
    v_max_f32_dpp v123, v123, v123 row_shr:2 row_mask:0xf bank_mask:0xf bound_ctrl:1
    v_max_f32_dpp v120, v120, v120 row_shr:4 row_mask:0xf bank_mask:0xf bound_ctrl:1
    v_max_f32_dpp v121, v121, v121 row_shr:4 row_mask:0xf bank_mask:0xf bound_ctrl:1
    v_max_f32_dpp v122, v122, v122 row_shr:4 row_mask:0xf bank_mask:0xf bound_ctrl:1
    v_max_f32_dpp v123, v123, v123 row_shr:4 row_mask:0xf bank_mask:0xf bound_ctrl:1
    v_max_f32_dpp v120, v120, v120 row_shr:8 row_mask:0xf bank_mask:0xf bound_ctrl:1
    v_max_f32_dpp v121, v121, v121 row_shr:8 row_mask:0xf bank_mask:0xf bound_ctrl:1
    v_max_f32_dpp v122, v122, v122 row_shr:8 row_mask:0xf bank_mask:0xf bound_ctrl:1
    v_max_f32_dpp v123, v123, v123 row_shr:8 row_mask:0xf bank_mask:0xf bound_ctrl:1
    v_max_f32_dpp v120, v120, v120 row_bcast:15 row_mask:0xa bank_mask:0xf
    v_max_f32_dpp v121, v121, v121 row_bcast:15 row_mask:0xa bank_mask:0xf
    v_max_f32_dpp v122, v122, v122 row_bcast:15 row_mask:0xa bank_mask:0xf
    v_max_f32_dpp v123, v123, v123 row_bcast:15 row_mask:0xa bank_mask:0xf
    s_lshl_b32 s69, s68, 2
    s_add_u32 s69, s69, 6291456
    v_mov_b32 v128, s69
    s_mov_b32 exec_lo, 0x80000000
    s_mov_b32 exec_hi, 0
    buffer_store_dword v120, v128, s[4:7], 0 offen offset:0 sc1
    buffer_store_dword v121, v128, s[4:7], 0 offen offset:256 sc1
    buffer_store_dword v122, v128, s[4:7], 0 offen offset:512 sc1
    buffer_store_dword v123, v128, s[4:7], 0 offen offset:768 sc1
    s_mov_b64 exec, -1
    s_branch L_epD_22
L_epV_21:
    s_lshl_b32 s69, s68, 12
    s_add_u32 s69, s69, 2048
    v_add_u32 v13, s69, v12
    s_mov_b32 s72, 0xf0000000
    s_mov_b32 s73, 0xf0000000
    v_and_b32 v14, 31, v1
    v_cmp_eq_u32 vcc, 28, v14
    v_mov_b32 v15, 0x3f803f80
    s_nop 0
    v_cndmask_b32 v15, 0, v15, vcc
    v_cvt_pk_bf16_f32 v80, v16, v17
    v_cvt_pk_bf16_f32 v81, v18, v19
    v_cvt_pk_bf16_f32 v82, v20, v21
    v_cvt_pk_bf16_f32 v83, v22, v23
    v_cvt_pk_bf16_f32 v84, v24, v25
    v_cvt_pk_bf16_f32 v85, v26, v27
    v_cvt_pk_bf16_f32 v86, v28, v29
    v_cvt_pk_bf16_f32 v87, v30, v31
    v_cndmask_b32 v80, v80, v15, s[72:73]
    v_cndmask_b32 v81, v81, v15, s[72:73]
    v_cndmask_b32 v82, v82, v15, s[72:73]
    v_cndmask_b32 v83, v83, v15, s[72:73]
    v_cndmask_b32 v84, v84, v15, s[72:73]
    v_cndmask_b32 v85, v85, v15, s[72:73]
    v_cndmask_b32 v86, v86, v15, s[72:73]
    v_cndmask_b32 v87, v87, v15, s[72:73]
    s_mov_b32 s71, 0
    buffer_store_dwordx4 v[80:83], v13, s[4:7], s71 offen offset:0 sc1
    buffer_store_dwordx4 v[84:87], v13, s[4:7], s71 offen offset:1024 sc1
    v_cvt_pk_bf16_f32 v88, v32, v33
    v_cvt_pk_bf16_f32 v89, v34, v35
    v_cvt_pk_bf16_f32 v90, v36, v37
    v_cvt_pk_bf16_f32 v91, v38, v39
    v_cvt_pk_bf16_f32 v92, v40, v41
    v_cvt_pk_bf16_f32 v93, v42, v43
    v_cvt_pk_bf16_f32 v94, v44, v45
    v_cvt_pk_bf16_f32 v95, v46, v47
    v_cndmask_b32 v88, v88, v15, s[72:73]
    v_cndmask_b32 v89, v89, v15, s[72:73]
    v_cndmask_b32 v90, v90, v15, s[72:73]
    v_cndmask_b32 v91, v91, v15, s[72:73]
    v_cndmask_b32 v92, v92, v15, s[72:73]
    v_cndmask_b32 v93, v93, v15, s[72:73]
    v_cndmask_b32 v94, v94, v15, s[72:73]
    v_cndmask_b32 v95, v95, v15, s[72:73]
    s_mov_b32 s71, 262144
    buffer_store_dwordx4 v[88:91], v13, s[4:7], s71 offen offset:0 sc1
    buffer_store_dwordx4 v[92:95], v13, s[4:7], s71 offen offset:1024 sc1
    v_cvt_pk_bf16_f32 v96, v48, v49
    v_cvt_pk_bf16_f32 v97, v50, v51
    v_cvt_pk_bf16_f32 v98, v52, v53
    v_cvt_pk_bf16_f32 v99, v54, v55
    v_cvt_pk_bf16_f32 v100, v56, v57
    v_cvt_pk_bf16_f32 v101, v58, v59
    v_cvt_pk_bf16_f32 v102, v60, v61
    v_cvt_pk_bf16_f32 v103, v62, v63
    v_cndmask_b32 v96, v96, v15, s[72:73]
    v_cndmask_b32 v97, v97, v15, s[72:73]
    v_cndmask_b32 v98, v98, v15, s[72:73]
    v_cndmask_b32 v99, v99, v15, s[72:73]
    v_cndmask_b32 v100, v100, v15, s[72:73]
    v_cndmask_b32 v101, v101, v15, s[72:73]
    v_cndmask_b32 v102, v102, v15, s[72:73]
    v_cndmask_b32 v103, v103, v15, s[72:73]
    s_mov_b32 s71, 524288
    buffer_store_dwordx4 v[96:99], v13, s[4:7], s71 offen offset:0 sc1
    buffer_store_dwordx4 v[100:103], v13, s[4:7], s71 offen offset:1024 sc1
    v_cvt_pk_bf16_f32 v104, v64, v65
    v_cvt_pk_bf16_f32 v105, v66, v67
    v_cvt_pk_bf16_f32 v106, v68, v69
    v_cvt_pk_bf16_f32 v107, v70, v71
    v_cvt_pk_bf16_f32 v108, v72, v73
    v_cvt_pk_bf16_f32 v109, v74, v75
    v_cvt_pk_bf16_f32 v110, v76, v77
    v_cvt_pk_bf16_f32 v111, v78, v79
    v_cndmask_b32 v104, v104, v15, s[72:73]
    v_cndmask_b32 v105, v105, v15, s[72:73]
    v_cndmask_b32 v106, v106, v15, s[72:73]
    v_cndmask_b32 v107, v107, v15, s[72:73]
    v_cndmask_b32 v108, v108, v15, s[72:73]
    v_cndmask_b32 v109, v109, v15, s[72:73]
    v_cndmask_b32 v110, v110, v15, s[72:73]
    v_cndmask_b32 v111, v111, v15, s[72:73]
    s_mov_b32 s71, 786432
    buffer_store_dwordx4 v[104:107], v13, s[4:7], s71 offen offset:0 sc1
    buffer_store_dwordx4 v[108:111], v13, s[4:7], s71 offen offset:1024 sc1
L_epD_22:
    s_waitcnt vmcnt(0)
    v_mov_b32 v12, 160552
    v_mov_b32 v13, 1
    s_mov_b64 exec, 1
    ds_add_rtn_u32 v13, v12, v13
    s_mov_b64 exec, -1
    s_waitcnt lgkmcnt(0)
    v_readfirstlane_b32 s65, v13
    s_nop 3
    s_cmp_lg_u32 s65, 3
    s_cbranch_scc1 L_conv_4
    v_readfirstlane_b32 s74, v11
    s_nop 3
    s_cmp_eq_u32 s74, 16843009
    s_cbranch_scc1 L_initok_23
    v_mov_b32 v250, 0
    s_mov_b32 s74, 0
L_poll_24:
    buffer_load_dword v251, v250, s[40:43], 0 offen sc1
    s_waitcnt vmcnt(0)
    v_readfirstlane_b32 s75, v251
    s_add_u32 s74, s74, 1
    s_nop 2
    s_cmp_ge_u32 s75, 16843009
    s_cbranch_scc1 L_pollx_25
    s_cmp_ge_u32 s74, 65536
    s_cbranch_scc1 L_pollx_25
    s_sleep 1
    s_branch L_poll_24
L_pollx_25:
L_initok_23:
    s_lshl_b32 s65, s62, 2
    s_add_u32 s65, s65, s63
    s_lshl_b32 s65, s65, 4
    s_add_u32 s65, s65, s64
    s_lshl_b32 s65, s65, 7
    s_add_u32 s65, s65, 6561792
    v_mov_b32 v250, s65
    v_mov_b32 v251, 1
    s_mov_b64 exec, 1
    buffer_store_dword v251, v250, s[4:7], 0 offen sc1
    s_mov_b64 exec, -1
    s_branch L_conv_4
L_brest_13:
    s_load_dwordx2 s[24:25], s[0:1], 48
    s_load_dwordx2 s[4:5], s[0:1], 96
    s_load_dwordx2 s[44:45], s[0:1], 56
    s_load_dwordx2 s[28:29], s[0:1], 72
    s_load_dwordx2 s[32:33], s[0:1], 16
    s_load_dwordx2 s[36:37], s[0:1], 80
    s_load_dwordx2 s[40:41], s[0:1], 88
    s_load_dwordx2 s[46:47], s[0:1], 64
    s_mov_b32 s26, 3584
    s_mov_b32 s27, 0x20000
    s_mov_b32 s30, 896
    s_mov_b32 s31, 0x20000
    s_mov_b32 s6, 16777216
    s_mov_b32 s7, 0x20000
    s_mov_b32 s34, 401408
    s_mov_b32 s35, 0x20000
    s_mov_b32 s38, 1835008
    s_mov_b32 s39, 0x20000
    s_mov_b32 s42, 256
    s_mov_b32 s43, 0x20000
    s_and_b32 s50, s2, 15
    s_lshr_b32 s51, s2, 4
    s_mul_i32 s65, s49, 24
    s_add_u32 s65, s65, s48
    s_lshl_b32 s65, s65, 1
    s_bfe_u32 s66, s3, 0x10001
    s_add_u32 s54, s65, s66
    s_mul_i32 s56, s66, 16640
    s_add_u32 s56, s56, 98304
    s_mul_i32 s57, s66, 4608
    s_add_u32 s57, s57, 131584
    s_lshl_b32 s58, s66, 13
    s_add_u32 s58, s58, 140800
    s_and_b32 s55, s3, 1
    s_cmp_lt_u32 s3, 4
    s_cselect_b32 s59, 1, 0
    s_lshl_b32 s65, s55, 11
    v_lshl_add_u32 v32, v1, 4, s65
    v_subrev_u32 v33, 16, v32
    v_add_u32 v34, 1008, v32
    v_cmp_eq_u32 vcc, 1, v1
    v_mov_b32 v35, 0x80000000
    v_mov_b32 v36, 4080
    v_cndmask_b32 v36, v35, v36, vcc
    v_mov_b32 v39, 0
    v_lshlrev_b32 v37, 2, v1
    v_add_u32 v37, 160544, v37
    s_mov_b64 exec, 0xff
    ds_write_b32 v37, v39
    s_mov_b64 exec, -1
    s_waitcnt lgkmcnt(0)
    s_mov_b32 s60, 3
L_ring_26:
    s_waitcnt vmcnt(8)
    s_barrier
    s_lshl_b32 s67, s72, 7
    s_mul_i32 s68, s72, 172032
    s_add_u32 s69, s71, s73
    s_add_u32 m0, s69, 0
    s_nop 0
    buffer_load_dwordx4 v2, s[8:11], s67 offen lds
    s_add_u32 m0, s69, 1024
    s_nop 0
    buffer_load_dwordx4 v3, s[8:11], s67 offen lds
    s_add_u32 m0, s69, 2048
    s_nop 0
    buffer_load_dwordx4 v4, s[8:11], s67 offen lds
    s_add_u32 m0, s69, 3072
    s_nop 0
    buffer_load_dwordx4 v5, s[8:11], s67 offen lds
    s_add_u32 m0, s69, 16384
    s_add_u32 s70, s68, 0
    buffer_load_dwordx4 v6, s[12:15], s70 offen lds
    s_add_u32 m0, s69, 17408
    s_add_u32 s70, s68, 10752
    buffer_load_dwordx4 v6, s[12:15], s70 offen lds
    s_add_u32 m0, s69, 18432
    s_add_u32 s70, s68, 21504
    buffer_load_dwordx4 v6, s[12:15], s70 offen lds
    s_add_u32 m0, s69, 19456
    s_add_u32 s70, s68, 32256
    buffer_load_dwordx4 v6, s[12:15], s70 offen lds
    s_add_u32 s72, s72, 1
    s_cmp_eq_u32 s72, 7
    s_cselect_b32 s72, 0, s72
    s_add_u32 s73, s73, 0x8000
    s_and_b32 s73, s73, 0x1ffff
    s_sub_u32 s60, s60, 1
    s_cmp_lg_u32 s60, 0
    s_cbranch_scc1 L_ring_26
    s_waitcnt vmcnt(8)
    s_barrier
    s_lshl_b32 s67, s72, 7
    s_mul_i32 s68, s72, 172032
    s_add_u32 s69, s71, s73
    s_add_u32 m0, s69, 0
    s_nop 0
    buffer_load_dwordx4 v2, s[8:11], s67 offen lds
    s_add_u32 m0, s69, 1024
    s_nop 0
    buffer_load_dwordx4 v3, s[8:11], s67 offen lds
    s_add_u32 m0, s69, 2048
    s_nop 0
    buffer_load_dwordx4 v4, s[8:11], s67 offen lds
    s_add_u32 m0, s69, 3072
    s_nop 0
    buffer_load_dwordx4 v5, s[8:11], s67 offen lds
    s_add_u32 m0, s69, 16384
    s_add_u32 s70, s68, 0
    buffer_load_dwordx4 v6, s[12:15], s70 offen lds
    s_add_u32 m0, s69, 17408
    s_add_u32 s70, s68, 10752
    buffer_load_dwordx4 v6, s[12:15], s70 offen lds
    s_add_u32 m0, s69, 18432
    s_add_u32 s70, s68, 21504
    buffer_load_dwordx4 v6, s[12:15], s70 offen lds
    s_add_u32 m0, s69, 19456
    s_add_u32 s70, s68, 32256
    buffer_load_dwordx4 v6, s[12:15], s70 offen lds
    s_add_u32 s72, s72, 1
    s_cmp_eq_u32 s72, 7
    s_cselect_b32 s72, 0, s72
    s_add_u32 s73, s73, 0x8000
    s_and_b32 s73, s73, 0x1ffff
    s_waitcnt vmcnt(8)
    s_barrier
    s_lshl_b32 s67, s72, 7
    s_mul_i32 s68, s72, 172032
    s_add_u32 s69, s71, s73
    s_add_u32 m0, s69, 0
    s_nop 0
    buffer_load_dwordx4 v2, s[8:11], s67 offen lds
    s_add_u32 m0, s69, 1024
    s_nop 0
    buffer_load_dwordx4 v3, s[8:11], s67 offen lds
    s_add_u32 m0, s69, 2048
    s_nop 0
    buffer_load_dwordx4 v4, s[8:11], s67 offen lds
    s_add_u32 m0, s69, 3072
    s_nop 0
    buffer_load_dwordx4 v5, s[8:11], s67 offen lds
    s_add_u32 m0, s69, 16384
    s_add_u32 s70, s68, 0
    buffer_load_dwordx4 v6, s[12:15], s70 offen lds
    s_add_u32 m0, s69, 17408
    s_add_u32 s70, s68, 10752
    buffer_load_dwordx4 v6, s[12:15], s70 offen lds
    s_add_u32 m0, s69, 18432
    s_add_u32 s70, s68, 21504
    buffer_load_dwordx4 v6, s[12:15], s70 offen lds
    s_add_u32 m0, s69, 19456
    s_add_u32 s70, s68, 32256
    buffer_load_dwordx4 v6, s[12:15], s70 offen lds
    s_add_u32 s72, s72, 1
    s_cmp_eq_u32 s72, 7
    s_cselect_b32 s72, 0, s72
    s_add_u32 s73, s73, 0x8000
    s_and_b32 s73, s73, 0x1ffff
    s_lshl_b32 s65, s54, 12
    s_add_u32 s68, s44, s65
    s_addc_u32 s69, s45, 0
    s_movk_i32 s70, 4096
    s_mov_b32 s71, 0x20000
    buffer_load_dwordx4 v[44:47], v33, s[68:71], 0 offen
    buffer_load_dwordx4 v[48:51], v32, s[68:71], 0 offen
    buffer_load_dwordx4 v[52:55], v34, s[68:71], 0 offen
    buffer_load_dwordx4 v[56:59], v32, s[68:71], 0 offen offset:1024
    buffer_load_dwordx4 v[60:63], v36, s[68:71], 0 offen
    buffer_load_dword v40, v39, s[40:43], 0 offen sc1
    s_waitcnt vmcnt(14)
    s_barrier
    s_waitcnt vmcnt(6)
    s_barrier
    s_barrier
    s_waitcnt vmcnt(0)
    v_add_u32 v6, s56, v32
    v_mov_b32 v64, 0
    v_mov_b32 v65, 0
    v_mov_b32 v66, 0
    v_mov_b32 v67, 0
    ds_write_b128 v6, v[44:47] offset:16
    v_alignbit_b32 v80, v45, v44, 16
    v_alignbit_b32 v81, v46, v45, 16
    v_alignbit_b32 v82, v47, v46, 16
    v_alignbit_b32 v83, v48, v47, 16
    v_mov_b32 v84, v45
    v_mov_b32 v85, v46
    v_mov_b32 v86, v47
    v_mov_b32 v87, v48
    v_alignbit_b32 v88, v46, v45, 16
    v_alignbit_b32 v89, v47, v46, 16
    v_alignbit_b32 v90, v48, v47, 16
    v_alignbit_b32 v91, v49, v48, 16
    ds_write_b128 v6, v[80:83] offset:4176
    ds_write_b128 v6, v[84:87] offset:8336
    ds_write_b128 v6, v[88:91] offset:12496
    ds_write_b128 v6, v[52:55] offset:1040
    v_alignbit_b32 v80, v53, v52, 16
    v_alignbit_b32 v81, v54, v53, 16
    v_alignbit_b32 v82, v55, v54, 16
    v_alignbit_b32 v83, v56, v55, 16
    v_mov_b32 v84, v53
    v_mov_b32 v85, v54
    v_mov_b32 v86, v55
    v_mov_b32 v87, v56
    v_alignbit_b32 v88, v54, v53, 16
    v_alignbit_b32 v89, v55, v54, 16
    v_alignbit_b32 v90, v56, v55, 16
    v_alignbit_b32 v91, v57, v56, 16
    ds_write_b128 v6, v[80:83] offset:5200
    ds_write_b128 v6, v[84:87] offset:9360
    ds_write_b128 v6, v[88:91] offset:13520
    v_mul_u32_u24 v7, 4112, v1
    v_add_u32 v7, s56, v7
    s_mov_b64 exec, 3
    ds_write_b128 v7, v[60:63] offset:0
    v_alignbit_b32 v80, v61, v60, 16
    v_alignbit_b32 v81, v62, v61, 16
    v_alignbit_b32 v82, v63, v62, 16
    v_alignbit_b32 v83, v64, v63, 16
    v_mov_b32 v84, v61
    v_mov_b32 v85, v62
    v_mov_b32 v86, v63
    v_mov_b32 v87, v64
    v_alignbit_b32 v88, v62, v61, 16
    v_alignbit_b32 v89, v63, v62, 16
    v_alignbit_b32 v90, v64, v63, 16
    v_alignbit_b32 v91, v65, v64, 16
    ds_write_b128 v7, v[80:83] offset:4160
    ds_write_b128 v7, v[84:87] offset:8320
    ds_write_b128 v7, v[88:91] offset:12480
    s_mov_b64 exec, -1
    v_lshl_add_u32 v7, v1, 4, s57
    s_mov_b32 exec_hi, 0
    ds_write_b128 v7, v[64:67] offset:4096
    s_mov_b64 exec, -1
    s_cmp_lg_u32 s3, 4
    s_cbranch_scc1 L_follow_27
    v_readfirstlane_b32 s74, v40
    s_nop 3
    s_cmp_eq_u32 s74, 16843009
    s_cbranch_scc1 L_initok_29
    v_mov_b32 v250, 0
    s_mov_b32 s74, 0
L_poll_30:
    buffer_load_dword v251, v250, s[40:43], 0 offen sc1
    s_waitcnt vmcnt(0)
    v_readfirstlane_b32 s75, v251
    s_add_u32 s74, s74, 1
    s_nop 2
    s_cmp_ge_u32 s75, 16843009
    s_cbranch_scc1 L_pollx_31
    s_cmp_ge_u32 s74, 65536
    s_cbranch_scc1 L_pollx_31
    s_sleep 1
    s_branch L_poll_30
L_pollx_31:
L_initok_29:
    v_lshlrev_b32 v250, 7, v1
    v_add_u32 v250, 6553600, v250
    s_mov_b32 s74, 0
    s_mov_b64 exec, -1
L_pollm_32:
    buffer_load_dword v251, v250, s[4:7], 0 offen sc1
    s_waitcnt vmcnt(0)
    v_cmp_gt_u32 vcc, 1, v251
    s_add_u32 s74, s74, 1
    s_nop 2
    s_cmp_eq_u64 vcc, 0
    s_cbranch_scc1 L_pollmx_33
    s_cmp_ge_u32 s74, 65536
    s_cbranch_scc1 L_pollmx_33
    s_sleep 2
    s_branch L_pollm_32
L_pollmx_33:
    s_mov_b64 exec, -1
    v_mov_b32 v250, 160548
    v_mov_b32 v251, 1
    ds_write_b32 v250, v251
    s_branch L_fjoin_28
L_follow_27:
    v_mov_b32 v250, 160548
    s_mov_b32 s74, 0
L_lf_34:
    ds_read_b32 v251, v250
    s_waitcnt lgkmcnt(0)
    v_readfirstlane_b32 s75, v251
    s_add_u32 s74, s74, 1
    s_nop 2
    s_cmp_eq_u32 s75, 1
    s_cbranch_scc1 L_lfx_35
    s_cmp_ge_u32 s74, 1048576
    s_cbranch_scc1 L_lfx_35
    s_sleep 1
    s_branch L_lf_34
L_lfx_35:
L_fjoin_28:
    s_lshl_b32 s53, s55, 1
    v_lshrrev_b32 v8, 2, v1
    v_sub_u32 v8, 63, v8
    v_mul_u32_u24 v8, 28672, v8
    v_and_b32 v9, 3, v1
    v_lshl_add_u32 v8, v9, 4, v8
    s_lshl_b32 s66, s54, 6
    s_add_u32 s66, s66, 7340032
    s_mul_i32 s67, s53, 458752
    s_sub_u32 s66, s66, s67
    s_lshl_b32 s67, s53, 10
    s_add_u32 s67, s67, s57
    s_add_u32 m0, s67, 0
    s_nop 0
    buffer_load_dwordx4 v8, s[4:7], s66 offen sc1 lds
    s_add_u32 m0, s67, 1024
    s_sub_u32 s66, s66, 458752
    buffer_load_dwordx4 v8, s[4:7], s66 offen sc1 lds
    s_branch L_b2_7
L_urest_10:
    s_load_dwordx2 s[24:25], s[0:1], 48
    s_load_dwordx2 s[4:5], s[0:1], 96
    s_load_dwordx2 s[44:45], s[0:1], 56
    s_load_dwordx2 s[28:29], s[0:1], 72
    s_load_dwordx2 s[32:33], s[0:1], 16
    s_load_dwordx2 s[36:37], s[0:1], 80
    s_load_dwordx2 s[40:41], s[0:1], 88
    s_load_dwordx2 s[46:47], s[0:1], 64
    s_mov_b32 s26, 3584
    s_mov_b32 s27, 0x20000
    s_mov_b32 s30, 896
    s_mov_b32 s31, 0x20000
    s_mov_b32 s6, 16777216
    s_mov_b32 s7, 0x20000
    s_mov_b32 s34, 401408
    s_mov_b32 s35, 0x20000
    s_mov_b32 s38, 1835008
    s_mov_b32 s39, 0x20000
    s_mov_b32 s42, 256
    s_mov_b32 s43, 0x20000
    s_and_b32 s50, s2, 15
    s_lshr_b32 s51, s2, 4
    s_mov_b32 s62, s67
    s_add_u32 s54, s67, 384
    s_mov_b32 s66, 0
    s_mul_i32 s56, s66, 16640
    s_add_u32 s56, s56, 98304
    s_mul_i32 s57, s66, 4608
    s_add_u32 s57, s57, 131584
    s_lshl_b32 s58, s66, 13
    s_add_u32 s58, s58, 140800
    s_and_b32 s55, s3, 1
    s_cmp_lt_u32 s3, 2
    s_cselect_b32 s59, 1, 0
    v_and_b32 v12, 31, v1
    v_lshrrev_b32 v13, 5, v1
    s_lshl_b32 s68, s3, 7
    v_mul_u32_u24 v14, 14336, v13
    v_lshl_add_u32 v14, v12, 2, v14
    v_add_u32 v4, s68, v14
    s_lshl_b32 s68, s3, 9
    s_cmp_lt_u32 s3, 7
    s_cselect_b32 s68, s68, 0x80000000
    v_lshl_add_u32 v5, v12, 4, s68
    s_lshl_b32 s68, s3, 12
    s_add_u32 s68, s68, 65536
    v_lshlrev_b32 v14, 7, v12
    v_add_u32 v14, s68, v14
    v_xor_b32 v15, 1, v13
    v_lshlrev_b32 v15, 1, v15
    v_and_b32 v10, 7, v12
    v_add_u32 v11, 0, v15
    v_xor_b32 v11, v11, v10
    v_lshl_add_u32 v6, v11, 4, v14
    v_add_u32 v11, 1, v15
    v_xor_b32 v11, v11, v10
    v_lshl_add_u32 v7, v11, 4, v14
    v_add_u32 v11, 4, v15
    v_xor_b32 v11, v11, v10
    v_lshl_add_u32 v8, v11, 4, v14
    v_add_u32 v11, 5, v15
    v_xor_b32 v11, v11, v10
    v_lshl_add_u32 v9, v11, 4, v14
    v_lshrrev_b32 v10, 3, v1
    v_and_b32 v11, 7, v1
    v_xor_b32 v11, v11, v10
    v_lshlrev_b32 v10, 7, v10
    v_lshl_add_u32 v10, v11, 4, v10
    v_add_u32 v10, s68, v10
    s_mul_i32 s68, s67, 28672
    s_lshl_b32 s69, s3, 12
    s_add_u32 s68, s68, s69
    s_add_u32 s68, s68, 7340032
    v_lshl_add_u32 v11, v1, 4, s68
    s_and_b32 s53, s3, 3
    s_lshl_b32 s68, s53, 10
    v_lshl_add_u32 v32, v1, 4, s68
    v_subrev_u32 v33, 16, v32
    v_cmp_eq_u32 vcc, 1, v1
    v_mov_b32 v35, 0x80000000
    v_mov_b32 v36, 4080
    v_cndmask_b32 v36, v35, v36, vcc
    v_mov_b32 v39, 0
    v_lshlrev_b32 v37, 2, v1
    v_add_u32 v37, 160544, v37
    s_mov_b64 exec, 0xff
    ds_write_b32 v37, v39
    s_mov_b64 exec, -1
    s_waitcnt lgkmcnt(0)
    buffer_load_dwordx4 v[136:139], v5, s[24:27], 0 offen
    s_lshr_b32 s65, s54, 1
    s_lshl_b32 s65, s65, 2
    s_load_dword s52, s[46:47], s65
    s_lshl_b32 s65, s54, 12
    s_add_u32 s68, s44, s65
    s_addc_u32 s69, s45, 0
    s_movk_i32 s70, 4096
    s_mov_b32 s71, 0x20000
    s_waitcnt vmcnt(0)
    s_barrier
    s_cmp_lt_u32 s3, 4
    s_cbranch_scc1 L_nohl_36
    buffer_load_dwordx4 v[44:47], v33, s[68:71], 0 offen
    buffer_load_dwordx4 v[48:51], v32, s[68:71], 0 offen
    buffer_load_dwordx4 v[52:55], v36, s[68:71], 0 offen
L_nohl_36:
    s_cmp_eq_u32 s3, 7
    s_cbranch_scc1 L_nou_37
    ds_read_b32 v100, v4 offset:0
    ds_read_b32 v101, v4 offset:896
    ds_read_b32 v102, v4 offset:1792
    ds_read_b32 v103, v4 offset:2688
    ds_read_b32 v104, v4 offset:3584
    ds_read_b32 v105, v4 offset:4480
    ds_read_b32 v106, v4 offset:5376
    ds_read_b32 v107, v4 offset:6272
    ds_read_b32 v108, v4 offset:7168
    ds_read_b32 v109, v4 offset:8064
    ds_read_b32 v110, v4 offset:8960
    ds_read_b32 v111, v4 offset:9856
    ds_read_b32 v112, v4 offset:10752
    ds_read_b32 v113, v4 offset:11648
    ds_read_b32 v114, v4 offset:12544
    ds_read_b32 v115, v4 offset:13440
    ds_read_b32 v116, v4 offset:14336
    ds_read_b32 v117, v4 offset:15232
    ds_read_b32 v118, v4 offset:16128
    ds_read_b32 v120, v4 offset:32768
    ds_read_b32 v121, v4 offset:33664
    ds_read_b32 v122, v4 offset:34560
    ds_read_b32 v123, v4 offset:35456
    ds_read_b32 v124, v4 offset:36352
    ds_read_b32 v125, v4 offset:37248
    ds_read_b32 v126, v4 offset:38144
    ds_read_b32 v127, v4 offset:39040
    ds_read_b32 v128, v4 offset:39936
    ds_read_b32 v129, v4 offset:40832
    ds_read_b32 v130, v4 offset:41728
    ds_read_b32 v131, v4 offset:42624
    ds_read_b32 v132, v4 offset:43520
    ds_read_b32 v133, v4 offset:44416
    ds_read_b32 v134, v4 offset:45312
    ds_read_b32 v135, v4 offset:46208
    v_lshlrev_b32 v140, 16, v136
    v_lshlrev_b32 v141, 16, v138
    v_and_b32 v142, 0xffff0000, v136
    v_and_b32 v143, 0xffff0000, v138
    v_lshlrev_b32 v144, 16, v137
    v_lshlrev_b32 v145, 16, v139
    v_and_b32 v146, 0xffff0000, v137
    v_and_b32 v147, 0xffff0000, v139
    s_waitcnt lgkmcnt(15)
    v_lshlrev_b32 v148, 16, v100
    v_and_b32 v149, 0xffff0000, v100
    v_lshlrev_b32 v150, 16, v101
    v_and_b32 v151, 0xffff0000, v101
    v_lshlrev_b32 v152, 16, v102
    v_and_b32 v153, 0xffff0000, v102
    v_lshlrev_b32 v154, 16, v103
    v_and_b32 v155, 0xffff0000, v103
    s_waitcnt lgkmcnt(8)
    v_lshlrev_b32 v156, 16, v104
    v_and_b32 v157, 0xffff0000, v104
    v_lshlrev_b32 v158, 16, v105
    v_and_b32 v159, 0xffff0000, v105
    v_lshlrev_b32 v160, 16, v106
    v_and_b32 v161, 0xffff0000, v106
    v_lshlrev_b32 v162, 16, v107
    v_and_b32 v163, 0xffff0000, v107
    v_lshlrev_b32 v164, 16, v108
    v_and_b32 v165, 0xffff0000, v108
    v_lshlrev_b32 v166, 16, v109
    v_and_b32 v167, 0xffff0000, v109
    v_lshlrev_b32 v168, 16, v110
    v_and_b32 v169, 0xffff0000, v110
    s_waitcnt lgkmcnt(0)
    v_lshlrev_b32 v170, 16, v111
    v_and_b32 v171, 0xffff0000, v111
    v_lshlrev_b32 v172, 16, v112
    v_and_b32 v173, 0xffff0000, v112
    v_lshlrev_b32 v174, 16, v113
    v_and_b32 v175, 0xffff0000, v113
    v_lshlrev_b32 v176, 16, v114
    v_and_b32 v177, 0xffff0000, v114
    v_lshlrev_b32 v178, 16, v115
    v_and_b32 v179, 0xffff0000, v115
    v_lshlrev_b32 v180, 16, v116
    v_and_b32 v181, 0xffff0000, v116
    v_lshlrev_b32 v182, 16, v117
    v_and_b32 v183, 0xffff0000, v117
    v_lshlrev_b32 v184, 16, v118
    v_and_b32 v185, 0xffff0000, v118
    v_lshlrev_b32 v186, 16, v120
    v_and_b32 v187, 0xffff0000, v120
    v_lshlrev_b32 v188, 16, v121
    v_and_b32 v189, 0xffff0000, v121
    v_lshlrev_b32 v190, 16, v122
    v_and_b32 v191, 0xffff0000, v122
    v_lshlrev_b32 v192, 16, v123
    v_and_b32 v193, 0xffff0000, v123
    v_lshlrev_b32 v194, 16, v124
    v_and_b32 v195, 0xffff0000, v124
    v_lshlrev_b32 v196, 16, v125
    v_and_b32 v197, 0xffff0000, v125
    v_lshlrev_b32 v198, 16, v126
    v_and_b32 v199, 0xffff0000, v126
    v_lshlrev_b32 v200, 16, v127
    v_and_b32 v201, 0xffff0000, v127
    v_lshlrev_b32 v202, 16, v128
    v_and_b32 v203, 0xffff0000, v128
    v_lshlrev_b32 v204, 16, v129
    v_and_b32 v205, 0xffff0000, v129
    v_lshlrev_b32 v206, 16, v130
    v_and_b32 v207, 0xffff0000, v130
    v_lshlrev_b32 v208, 16, v131
    v_and_b32 v209, 0xffff0000, v131
    v_lshlrev_b32 v210, 16, v132
    v_and_b32 v211, 0xffff0000, v132
    v_lshlrev_b32 v212, 16, v133
    v_and_b32 v213, 0xffff0000, v133
    v_lshlrev_b32 v214, 16, v134
    v_and_b32 v215, 0xffff0000, v134
    v_lshlrev_b32 v216, 16, v135
    v_and_b32 v217, 0xffff0000, v135
    v_pk_mul_f32 v[60:61], v[146:147], v[148:149]
    v_pk_mul_f32 v[62:63], v[146:147], v[150:151]
    v_pk_mul_f32 v[64:65], v[146:147], v[152:153]
    v_pk_mul_f32 v[66:67], v[146:147], v[154:155]
    v_pk_mul_f32 v[68:69], v[146:147], v[156:157]
    v_pk_mul_f32 v[70:71], v[146:147], v[158:159]
    v_pk_mul_f32 v[72:73], v[146:147], v[160:161]
    v_pk_mul_f32 v[74:75], v[146:147], v[162:163]
    v_pk_mul_f32 v[76:77], v[146:147], v[164:165]
    v_pk_mul_f32 v[78:79], v[146:147], v[166:167]
    v_pk_mul_f32 v[80:81], v[146:147], v[168:169]
    v_pk_mul_f32 v[82:83], v[146:147], v[170:171]
    v_pk_mul_f32 v[84:85], v[146:147], v[172:173]
    v_pk_mul_f32 v[86:87], v[146:147], v[174:175]
    v_pk_mul_f32 v[88:89], v[146:147], v[176:177]
    v_pk_mul_f32 v[90:91], v[146:147], v[178:179]
    v_pk_fma_f32 v[60:61], v[144:145], v[150:151], v[60:61]
    v_pk_fma_f32 v[62:63], v[144:145], v[152:153], v[62:63]
    v_pk_fma_f32 v[64:65], v[144:145], v[154:155], v[64:65]
    v_pk_fma_f32 v[66:67], v[144:145], v[156:157], v[66:67]
    v_pk_fma_f32 v[68:69], v[144:145], v[158:159], v[68:69]
    v_pk_fma_f32 v[70:71], v[144:145], v[160:161], v[70:71]
    v_pk_fma_f32 v[72:73], v[144:145], v[162:163], v[72:73]
    v_pk_fma_f32 v[74:75], v[144:145], v[164:165], v[74:75]
    v_pk_fma_f32 v[76:77], v[144:145], v[166:167], v[76:77]
    v_pk_fma_f32 v[78:79], v[144:145], v[168:169], v[78:79]
    v_pk_fma_f32 v[80:81], v[144:145], v[170:171], v[80:81]
    v_pk_fma_f32 v[82:83], v[144:145], v[172:173], v[82:83]
    v_pk_fma_f32 v[84:85], v[144:145], v[174:175], v[84:85]
    v_pk_fma_f32 v[86:87], v[144:145], v[176:177], v[86:87]
    v_pk_fma_f32 v[88:89], v[144:145], v[178:179], v[88:89]
    v_pk_fma_f32 v[90:91], v[144:145], v[180:181], v[90:91]
    v_pk_fma_f32 v[60:61], v[142:143], v[152:153], v[60:61]
    v_pk_fma_f32 v[62:63], v[142:143], v[154:155], v[62:63]
    v_pk_fma_f32 v[64:65], v[142:143], v[156:157], v[64:65]
    v_pk_fma_f32 v[66:67], v[142:143], v[158:159], v[66:67]
    v_pk_fma_f32 v[68:69], v[142:143], v[160:161], v[68:69]
    v_pk_fma_f32 v[70:71], v[142:143], v[162:163], v[70:71]
    v_pk_fma_f32 v[72:73], v[142:143], v[164:165], v[72:73]
    v_pk_fma_f32 v[74:75], v[142:143], v[166:167], v[74:75]
    v_pk_fma_f32 v[76:77], v[142:143], v[168:169], v[76:77]
    v_pk_fma_f32 v[78:79], v[142:143], v[170:171], v[78:79]
    v_pk_fma_f32 v[80:81], v[142:143], v[172:173], v[80:81]
    v_pk_fma_f32 v[82:83], v[142:143], v[174:175], v[82:83]
    v_pk_fma_f32 v[84:85], v[142:143], v[176:177], v[84:85]
    v_pk_fma_f32 v[86:87], v[142:143], v[178:179], v[86:87]
    v_pk_fma_f32 v[88:89], v[142:143], v[180:181], v[88:89]
    v_pk_fma_f32 v[90:91], v[142:143], v[182:183], v[90:91]
    v_pk_fma_f32 v[60:61], v[140:141], v[154:155], v[60:61]
    v_pk_fma_f32 v[62:63], v[140:141], v[156:157], v[62:63]
    v_pk_fma_f32 v[64:65], v[140:141], v[158:159], v[64:65]
    v_pk_fma_f32 v[66:67], v[140:141], v[160:161], v[66:67]
    v_pk_fma_f32 v[68:69], v[140:141], v[162:163], v[68:69]
    v_pk_fma_f32 v[70:71], v[140:141], v[164:165], v[70:71]
    v_pk_fma_f32 v[72:73], v[140:141], v[166:167], v[72:73]
    v_pk_fma_f32 v[74:75], v[140:141], v[168:169], v[74:75]
    v_pk_fma_f32 v[76:77], v[140:141], v[170:171], v[76:77]
    v_pk_fma_f32 v[78:79], v[140:141], v[172:173], v[78:79]
    v_pk_fma_f32 v[80:81], v[140:141], v[174:175], v[80:81]
    v_pk_fma_f32 v[82:83], v[140:141], v[176:177], v[82:83]
    v_pk_fma_f32 v[84:85], v[140:141], v[178:179], v[84:85]
    v_pk_fma_f32 v[86:87], v[140:141], v[180:181], v[86:87]
    v_pk_fma_f32 v[88:89], v[140:141], v[182:183], v[88:89]
    v_pk_fma_f32 v[90:91], v[140:141], v[184:185], v[90:91]
    v_pk_mul_f32 v[60:61], v[60:61], v[186:187]
    v_pk_mul_f32 v[62:63], v[62:63], v[188:189]
    v_pk_mul_f32 v[64:65], v[64:65], v[190:191]
    v_pk_mul_f32 v[66:67], v[66:67], v[192:193]
    v_pk_mul_f32 v[68:69], v[68:69], v[194:195]
    v_pk_mul_f32 v[70:71], v[70:71], v[196:197]
    v_pk_mul_f32 v[72:73], v[72:73], v[198:199]
    v_pk_mul_f32 v[74:75], v[74:75], v[200:201]
    v_pk_mul_f32 v[76:77], v[76:77], v[202:203]
    v_pk_mul_f32 v[78:79], v[78:79], v[204:205]
    v_pk_mul_f32 v[80:81], v[80:81], v[206:207]
    v_pk_mul_f32 v[82:83], v[82:83], v[208:209]
    v_pk_mul_f32 v[84:85], v[84:85], v[210:211]
    v_pk_mul_f32 v[86:87], v[86:87], v[212:213]
    v_pk_mul_f32 v[88:89], v[88:89], v[214:215]
    v_pk_mul_f32 v[90:91], v[90:91], v[216:217]
    v_cvt_pk_bf16_f32 v16, v90, v88
    v_cvt_pk_bf16_f32 v17, v86, v84
    v_cvt_pk_bf16_f32 v18, v82, v80
    v_cvt_pk_bf16_f32 v19, v78, v76
    v_cvt_pk_bf16_f32 v20, v74, v72
    v_cvt_pk_bf16_f32 v21, v70, v68
    v_cvt_pk_bf16_f32 v22, v66, v64
    v_cvt_pk_bf16_f32 v23, v62, v60
    v_cvt_pk_bf16_f32 v24, v91, v89
    v_cvt_pk_bf16_f32 v25, v87, v85
    v_cvt_pk_bf16_f32 v26, v83, v81
    v_cvt_pk_bf16_f32 v27, v79, v77
    v_cvt_pk_bf16_f32 v28, v75, v73
    v_cvt_pk_bf16_f32 v29, v71, v69
    v_cvt_pk_bf16_f32 v30, v67, v65
    v_cvt_pk_bf16_f32 v31, v63, v61
    ds_write_b128 v6, v[16:19]
    ds_write_b128 v7, v[20:23]
    ds_write_b128 v8, v[24:27]
    ds_write_b128 v9, v[28:31]
    s_waitcnt lgkmcnt(0)
    ds_read_b128 v[16:19], v10 offset:0
    ds_read_b128 v[20:23], v10 offset:1024
    ds_read_b128 v[24:27], v10 offset:2048
    ds_read_b128 v[28:31], v10 offset:3072
    s_waitcnt lgkmcnt(0)
    buffer_store_dwordx4 v[16:19], v11, s[4:7], 0 offen offset:0 sc1
    buffer_store_dwordx4 v[20:23], v11, s[4:7], 0 offen offset:1024 sc1
    buffer_store_dwordx4 v[24:27], v11, s[4:7], 0 offen offset:2048 sc1
    buffer_store_dwordx4 v[28:31], v11, s[4:7], 0 offen offset:3072 sc1
L_nou_37:
    buffer_load_dword v40, v39, s[40:43], 0 offen sc1
    s_cmp_lt_u32 s3, 4
    s_cbranch_scc1 L_nohb_38
    s_waitcnt vmcnt(5)
    s_cmp_lg_u32 s3, 7
    s_cbranch_scc1 L_w7_39
    s_waitcnt vmcnt(1)
L_w7_39:
    v_add_u32 v6, s56, v32
    v_mov_b32 v64, 0
    v_mov_b32 v65, 0
    v_mov_b32 v66, 0
    v_mov_b32 v67, 0
    ds_write_b128 v6, v[44:47] offset:16
    v_alignbit_b32 v80, v45, v44, 16
    v_alignbit_b32 v81, v46, v45, 16
    v_alignbit_b32 v82, v47, v46, 16
    v_alignbit_b32 v83, v48, v47, 16
    v_mov_b32 v84, v45
    v_mov_b32 v85, v46
    v_mov_b32 v86, v47
    v_mov_b32 v87, v48
    v_alignbit_b32 v88, v46, v45, 16
    v_alignbit_b32 v89, v47, v46, 16
    v_alignbit_b32 v90, v48, v47, 16
    v_alignbit_b32 v91, v49, v48, 16
    ds_write_b128 v6, v[80:83] offset:4176
    ds_write_b128 v6, v[84:87] offset:8336
    ds_write_b128 v6, v[88:91] offset:12496
    v_mul_u32_u24 v7, 4112, v1
    v_add_u32 v7, s56, v7
    s_mov_b64 exec, 3
    ds_write_b128 v7, v[52:55] offset:0
    v_alignbit_b32 v80, v53, v52, 16
    v_alignbit_b32 v81, v54, v53, 16
    v_alignbit_b32 v82, v55, v54, 16
    v_alignbit_b32 v83, v64, v55, 16
    v_mov_b32 v84, v53
    v_mov_b32 v85, v54
    v_mov_b32 v86, v55
    v_mov_b32 v87, v64
    v_alignbit_b32 v88, v54, v53, 16
    v_alignbit_b32 v89, v55, v54, 16
    v_alignbit_b32 v90, v64, v55, 16
    v_alignbit_b32 v91, v65, v64, 16
    ds_write_b128 v7, v[80:83] offset:4160
    ds_write_b128 v7, v[84:87] offset:8320
    ds_write_b128 v7, v[88:91] offset:12480
    s_mov_b64 exec, -1
    v_lshl_add_u32 v7, v1, 4, s57
    s_mov_b32 exec_hi, 0
    ds_write_b128 v7, v[64:67] offset:4096
    s_mov_b64 exec, -1
L_nohb_38:
    s_waitcnt vmcnt(0)
    s_barrier
    s_cmp_lt_u32 s3, 4
    s_cbranch_scc1 L_conv_4
    s_cmp_lg_u32 s3, 4
    s_cbranch_scc1 L_follow_40
    v_readfirstlane_b32 s74, v40
    s_nop 3
    s_cmp_eq_u32 s74, 16843009
    s_cbranch_scc1 L_initok_42
    v_mov_b32 v250, 0
    s_mov_b32 s74, 0
L_poll_43:
    buffer_load_dword v251, v250, s[40:43], 0 offen sc1
    s_waitcnt vmcnt(0)
    v_readfirstlane_b32 s75, v251
    s_add_u32 s74, s74, 1
    s_nop 2
    s_cmp_ge_u32 s75, 16843009
    s_cbranch_scc1 L_pollx_44
    s_cmp_ge_u32 s74, 65536
    s_cbranch_scc1 L_pollx_44
    s_sleep 1
    s_branch L_poll_43
L_pollx_44:
L_initok_42:
    s_lshl_b32 s65, s62, 7
    s_add_u32 s65, s65, 6553600
    v_mov_b32 v250, s65
    v_mov_b32 v251, 1
    s_mov_b64 exec, 1
    buffer_store_dword v251, v250, s[4:7], 0 offen sc1
    s_mov_b64 exec, -1
    v_lshlrev_b32 v250, 7, v1
    v_add_u32 v250, 6553600, v250
    s_mov_b32 s74, 0
    s_mov_b64 exec, -1
L_pollm_45:
    buffer_load_dword v251, v250, s[4:7], 0 offen sc1
    s_waitcnt vmcnt(0)
    v_cmp_gt_u32 vcc, 1, v251
    s_add_u32 s74, s74, 1
    s_nop 2
    s_cmp_eq_u64 vcc, 0
    s_cbranch_scc1 L_pollmx_46
    s_cmp_ge_u32 s74, 65536
    s_cbranch_scc1 L_pollmx_46
    s_sleep 2
    s_branch L_pollm_45
L_pollmx_46:
    s_mov_b64 exec, -1
    v_mov_b32 v250, 160548
    v_mov_b32 v251, 1
    ds_write_b32 v250, v251
    s_branch L_fjoin_41
L_follow_40:
    v_mov_b32 v250, 160548
    s_mov_b32 s74, 0
L_lf_47:
    ds_read_b32 v251, v250
    s_waitcnt lgkmcnt(0)
    v_readfirstlane_b32 s75, v251
    s_add_u32 s74, s74, 1
    s_nop 2
    s_cmp_eq_u32 s75, 1
    s_cbranch_scc1 L_lfx_48
    s_cmp_ge_u32 s74, 1048576
    s_cbranch_scc1 L_lfx_48
    s_sleep 1
    s_branch L_lf_47
L_lfx_48:
L_fjoin_41:
    v_lshrrev_b32 v8, 2, v1
    v_sub_u32 v8, 63, v8
    v_mul_u32_u24 v8, 28672, v8
    v_and_b32 v9, 3, v1
    v_lshl_add_u32 v8, v9, 4, v8
    s_lshl_b32 s66, s54, 6
    s_add_u32 s66, s66, 7340032
    s_mul_i32 s67, s53, 458752
    s_sub_u32 s66, s66, s67
    s_lshl_b32 s67, s53, 10
    s_add_u32 s67, s67, s57
    s_add_u32 m0, s67, 0
    s_nop 0
    buffer_load_dwordx4 v8, s[4:7], s66 offen sc1 lds
    s_branch L_b2_7
L_b2_7:
    s_sub_u32 s53, s3, 4
    s_lshl_b32 s67, s51, 7
    s_lshl_b32 s68, s50, 3
    s_add_u32 s67, s67, s68
    s_lshl_b32 s68, s53, 1
    s_add_u32 s69, s67, s68
    s_mul_i32 s67, s69, 896
    v_lshlrev_b32 v12, 4, v1
    v_add_u32 v13, s67, v12
    v_cmp_gt_u32 vcc, 56, v1
    v_mov_b32 v14, 0x80000000
    s_nop 0
    v_cndmask_b32 v13, v14, v13, vcc
    buffer_load_dwordx4 v[28:31], v12, s[28:31], 0 offen
    buffer_load_dwordx4 v[20:23], v13, s[8:11], 0 offen
    buffer_load_dwordx4 v[24:27], v13, s[8:11], 0 offen offset:896
    s_waitcnt vmcnt(3) lgkmcnt(0)
    s_barrier
    s_waitcnt vmcnt(0)
    v_mov_b32 v32, 0
    v_mov_b32 v33, 0
    v_lshlrev_b32 v34, 16, v28
    v_and_b32 v35, 0xffff0000, v28
    v_lshlrev_b32 v36, 16, v20
    v_and_b32 v37, 0xffff0000, v20
    v_lshlrev_b32 v38, 16, v24
    v_and_b32 v39, 0xffff0000, v24
    v_fmac_f32 v32, v34, v36
    v_fmac_f32 v33, v34, v38
    v_fmac_f32 v32, v35, v37
    v_fmac_f32 v33, v35, v39
    v_lshlrev_b32 v34, 16, v29
    v_and_b32 v35, 0xffff0000, v29
    v_lshlrev_b32 v36, 16, v21
    v_and_b32 v37, 0xffff0000, v21
    v_lshlrev_b32 v38, 16, v25
    v_and_b32 v39, 0xffff0000, v25
    v_fmac_f32 v32, v34, v36
    v_fmac_f32 v33, v34, v38
    v_fmac_f32 v32, v35, v37
    v_fmac_f32 v33, v35, v39
    v_lshlrev_b32 v34, 16, v30
    v_and_b32 v35, 0xffff0000, v30
    v_lshlrev_b32 v36, 16, v22
    v_and_b32 v37, 0xffff0000, v22
    v_lshlrev_b32 v38, 16, v26
    v_and_b32 v39, 0xffff0000, v26
    v_fmac_f32 v32, v34, v36
    v_fmac_f32 v33, v34, v38
    v_fmac_f32 v32, v35, v37
    v_fmac_f32 v33, v35, v39
    v_lshlrev_b32 v34, 16, v31
    v_and_b32 v35, 0xffff0000, v31
    v_lshlrev_b32 v36, 16, v23
    v_and_b32 v37, 0xffff0000, v23
    v_lshlrev_b32 v38, 16, v27
    v_and_b32 v39, 0xffff0000, v27
    v_fmac_f32 v32, v34, v36
    v_fmac_f32 v33, v34, v38
    v_fmac_f32 v32, v35, v37
    v_fmac_f32 v33, v35, v39
    s_nop 0
    v_add_f32_dpp v32, v32, v32 row_shr:1 row_mask:0xf bank_mask:0xf bound_ctrl:1
    v_add_f32_dpp v33, v33, v33 row_shr:1 row_mask:0xf bank_mask:0xf bound_ctrl:1
    s_nop 0
    v_add_f32_dpp v32, v32, v32 row_shr:2 row_mask:0xf bank_mask:0xf bound_ctrl:1
    v_add_f32_dpp v33, v33, v33 row_shr:2 row_mask:0xf bank_mask:0xf bound_ctrl:1
    s_nop 0
    v_add_f32_dpp v32, v32, v32 row_shr:4 row_mask:0xf bank_mask:0xf bound_ctrl:1
    v_add_f32_dpp v33, v33, v33 row_shr:4 row_mask:0xf bank_mask:0xf bound_ctrl:1
    s_nop 0
    v_add_f32_dpp v32, v32, v32 row_shr:8 row_mask:0xf bank_mask:0xf bound_ctrl:1
    v_add_f32_dpp v33, v33, v33 row_shr:8 row_mask:0xf bank_mask:0xf bound_ctrl:1
    s_nop 0
    v_add_f32_dpp v32, v32, v32 row_bcast:15 row_mask:0xa bank_mask:0xf
    v_add_f32_dpp v33, v33, v33 row_bcast:15 row_mask:0xa bank_mask:0xf
    s_nop 0
    v_add_f32_dpp v32, v32, v32 row_bcast:31 row_mask:0xc bank_mask:0xf
    v_add_f32_dpp v33, v33, v33 row_bcast:31 row_mask:0xc bank_mask:0xf
    v_mul_f32 v32, 0xbfb8aa3b, v32
    v_mul_f32 v33, 0xbfb8aa3b, v33
    v_exp_f32 v32, v32
    v_exp_f32 v33, v33
    v_add_f32 v32, 1.0, v32
    v_add_f32 v33, 1.0, v33
    v_rcp_f32 v32, v32
    v_rcp_f32 v33, v33
    s_lshl_b32 s69, s69, 2
    s_add_u32 s69, s69, 6356992
    v_mov_b32 v34, s69
    s_mov_b32 exec_lo, 0
    s_mov_b32 exec_hi, 0x80000000
    buffer_store_dwordx2 v[32:33], v34, s[4:7], 0 offen sc1
    s_mov_b64 exec, -1
    s_cmp_lg_u32 s3, 4
    s_cbranch_scc1 L_follow_49
    s_lshr_b32 s65, s50, 2
    s_lshl_b32 s65, s65, 4
    v_and_b32 v250, 15, v1
    v_lshrrev_b32 v251, 4, v1
    v_add_u32 v251, 1, v251
    v_lshlrev_b32 v251, 6, v251
    v_add_u32 v250, v250, v251
    v_mov_b32 v251, s51
    v_cmp_eq_u32 vcc, 32, v1
    s_nop 1
    v_cndmask_b32 v250, v250, v251, vcc
    v_add_u32 v250, s65, v250
    v_lshlrev_b32 v250, 7, v250
    v_add_u32 v250, 6561792, v250
    s_mov_b32 s74, 0
    s_mov_b32 exec_lo, -1
    s_mov_b32 exec_hi, 1
L_pollm_51:
    buffer_load_dword v249, v250, s[4:7], 0 offen sc1
    s_waitcnt vmcnt(0)
    v_cmp_gt_u32 vcc, 1, v249
    s_add_u32 s74, s74, 1
    s_nop 2
    s_cmp_eq_u64 vcc, 0
    s_cbranch_scc1 L_pollmx_52
    s_cmp_ge_u32 s74, 65536
    s_cbranch_scc1 L_pollmx_52
    s_sleep 2
    s_branch L_pollm_51
L_pollmx_52:
    s_mov_b64 exec, -1
    v_mov_b32 v250, 160544
    v_mov_b32 v251, 1
    ds_write_b32 v250, v251
    s_branch L_fjoin_50
L_follow_49:
    v_mov_b32 v250, 160544
    s_mov_b32 s74, 0
L_lf_53:
    ds_read_b32 v251, v250
    s_waitcnt lgkmcnt(0)
    v_readfirstlane_b32 s75, v251
    s_add_u32 s74, s74, 1
    s_nop 2
    s_cmp_eq_u32 s75, 1
    s_cbranch_scc1 L_lfx_54
    s_cmp_ge_u32 s74, 1048576
    s_cbranch_scc1 L_lfx_54
    s_sleep 1
    s_branch L_lf_53
L_lfx_54:
L_fjoin_50:
    s_lshl_b32 s66, s50, 6
    s_lshl_b32 s67, s51, 2
    s_add_u32 s66, s66, s67
    s_add_u32 s66, s66, s53
    s_lshl_b32 s66, s66, 11
    s_add_u32 s66, s66, 4194304
    v_lshlrev_b32 v12, 4, v1
    s_lshl_b32 s67, s53, 11
    s_add_u32 m0, s67, 65536
    s_nop 0
    buffer_load_dwordx4 v12, s[4:7], s66 offen sc1 lds
    buffer_load_dwordx4 v12, s[4:7], s66 offen offset:1024 sc1 lds
    s_lshl_b32 s66, s50, 8
    s_add_u32 s66, s66, 6291456
    v_lshlrev_b32 v13, 2, v1
    buffer_load_dword v203, v13, s[4:7], s66 offen sc1
    s_add_u32 s68, s67, 65536
    v_add_u32 v201, s68, v12
    s_sub_u32 s65, s3, 4
    s_lshl_b32 s66, s50, 6
    s_add_u32 s66, s66, s65
    s_lshl_b32 s66, s66, 12
    s_add_u32 s66, s66, 0
    v_lshl_add_u32 v200, v1, 4, s66
    s_lshl_b32 s66, s65, 12
    s_add_u32 m0, s66, 0
    s_mov_b32 s67, 0
    buffer_load_dwordx4 v200, s[4:7], s67 offen offset:0 sc1 lds
    buffer_load_dwordx4 v200, s[4:7], s67 offen offset:1024 sc1 lds
    buffer_load_dwordx4 v200, s[4:7], s67 offen offset:2048 sc1 lds
    buffer_load_dwordx4 v200, s[4:7], s67 offen offset:3072 sc1 lds
    s_add_u32 m0, s66, 16384
    s_mov_b32 s67, 131072
    buffer_load_dwordx4 v200, s[4:7], s67 offen offset:0 sc1 lds
    buffer_load_dwordx4 v200, s[4:7], s67 offen offset:1024 sc1 lds
    buffer_load_dwordx4 v200, s[4:7], s67 offen offset:2048 sc1 lds
    buffer_load_dwordx4 v200, s[4:7], s67 offen offset:3072 sc1 lds
    s_add_u32 m0, s66, 32768
    s_mov_b32 s67, 16384
    buffer_load_dwordx4 v200, s[4:7], s67 offen offset:0 sc1 lds
    buffer_load_dwordx4 v200, s[4:7], s67 offen offset:1024 sc1 lds
    buffer_load_dwordx4 v200, s[4:7], s67 offen offset:2048 sc1 lds
    buffer_load_dwordx4 v200, s[4:7], s67 offen offset:3072 sc1 lds
    s_add_u32 m0, s66, 49152
    s_mov_b32 s67, 147456
    buffer_load_dwordx4 v200, s[4:7], s67 offen offset:0 sc1 lds
    buffer_load_dwordx4 v200, s[4:7], s67 offen offset:1024 sc1 lds
    buffer_load_dwordx4 v200, s[4:7], s67 offen offset:2048 sc1 lds
    buffer_load_dwordx4 v200, s[4:7], s67 offen offset:3072 sc1 lds
    s_waitcnt vmcnt(16)
    ds_read_b128 v[204:207], v201
    ds_read_b128 v[208:211], v201 offset:1024
    v_max_f32_dpp v203, v203, v203 row_shr:1 row_mask:0xf bank_mask:0xf bound_ctrl:1
    s_nop 1
    v_max_f32_dpp v203, v203, v203 row_shr:2 row_mask:0xf bank_mask:0xf bound_ctrl:1
    s_nop 1
    v_max_f32_dpp v203, v203, v203 row_shr:4 row_mask:0xf bank_mask:0xf bound_ctrl:1
    s_nop 1
    v_max_f32_dpp v203, v203, v203 row_shr:8 row_mask:0xf bank_mask:0xf bound_ctrl:1
    s_nop 1
    v_max_f32_dpp v203, v203, v203 row_bcast:15 row_mask:0xa bank_mask:0xf
    s_nop 1
    v_max_f32_dpp v203, v203, v203 row_bcast:31 row_mask:0xc bank_mask:0xf
    s_nop 0
    v_readlane_b32 s67, v203, 63
    v_mov_b32 v8, 0
    s_waitcnt lgkmcnt(0)
    v_lshlrev_b32 v9, 16, v204
    v_and_b32 v10, 0xffff0000, v204
    v_fmac_f32 v8, v9, v9
    v_fmac_f32 v8, v10, v10
    v_lshlrev_b32 v9, 16, v205
    v_and_b32 v10, 0xffff0000, v205
    v_fmac_f32 v8, v9, v9
    v_fmac_f32 v8, v10, v10
    v_lshlrev_b32 v9, 16, v206
    v_and_b32 v10, 0xffff0000, v206
    v_fmac_f32 v8, v9, v9
    v_fmac_f32 v8, v10, v10
    v_lshlrev_b32 v9, 16, v207
    v_and_b32 v10, 0xffff0000, v207
    v_fmac_f32 v8, v9, v9
    v_fmac_f32 v8, v10, v10
    v_lshlrev_b32 v9, 16, v208
    v_and_b32 v10, 0xffff0000, v208
    v_fmac_f32 v8, v9, v9
    v_fmac_f32 v8, v10, v10
    v_lshlrev_b32 v9, 16, v209
    v_and_b32 v10, 0xffff0000, v209
    v_fmac_f32 v8, v9, v9
    v_fmac_f32 v8, v10, v10
    v_lshlrev_b32 v9, 16, v210
    v_and_b32 v10, 0xffff0000, v210
    v_fmac_f32 v8, v9, v9
    v_fmac_f32 v8, v10, v10
    v_lshlrev_b32 v9, 16, v211
    v_and_b32 v10, 0xffff0000, v211
    v_fmac_f32 v8, v9, v9
    v_fmac_f32 v8, v10, v10
    v_mov_b32 v9, v8
    s_nop 1
    v_permlane32_swap_b32 v8, v9
    v_add_f32 v8, v8, v9
    v_mul_f32 v8, s67, v8
    v_sqrt_f32 v8, v8
    s_nop 0
    v_mul_f32 v8, 0x3f828f5c, v8
    v_mov_b32 v9, 0x42400000
    v_cmp_nle_f32 vcc, v8, v9
    s_nop 3
    s_cmp_lg_u64 vcc, 0
    s_cselect_b32 s67, 1, 0
    v_mov_b32 v9, s67
    s_lshl_b32 s68, s53, 2
    s_add_u32 s68, s68, 160512
    v_mov_b32 v10, s68
    ds_write_b32 v10, v9
    s_lshl_b32 s68, s53, 8
    s_add_u32 s68, s68, 74240
    v_lshl_add_u32 v10, v1, 2, s68
    ds_write_b32 v10, v8
    s_waitcnt vmcnt(8) lgkmcnt(0)
    s_branch L_cv2_5
L_conv_4:
    s_lshl_b32 s72, s55, 8
    v_and_b32 v2, 15, v1
    v_lshrrev_b32 v3, 4, v1
    v_add_u32 v4, 1, v2
    v_and_b32 v5, 3, v4
    v_mul_u32_u24 v5, 4160, v5
    v_lshrrev_b32 v4, 2, v4
    v_lshl_add_u32 v4, v3, 1, v4
    v_lshl_add_u32 v5, v4, 3, v5
    s_add_u32 s73, s56, s72
    v_add_u32 v6, s73, v5
    v_lshlrev_b32 v4, 1, v2
    v_sub_u32 v4, v3, v4
    v_lshlrev_b32 v4, 4, v4
    s_add_u32 s73, s57, 480
    s_add_u32 s73, s73, s72
    v_add_u32 v7, s73, v4
    v_mov_b32 v8, 0
    v_mov_b32 v9, 0
    v_mov_b32 v10, 0
    v_mov_b32 v11, 0
    v_mov_b32 v12, 0
    v_mov_b32 v13, 0
    v_mov_b32 v14, 0
    v_mov_b32 v15, 0
    v_mov_b32 v16, 0
    v_mov_b32 v17, 0
    v_mov_b32 v18, 0
    v_mov_b32 v19, 0
    v_mov_b32 v20, 0
    v_mov_b32 v21, 0
    v_mov_b32 v22, 0
    v_mov_b32 v23, 0
    v_mov_b32 v24, 0
    v_mov_b32 v25, 0
    v_mov_b32 v26, 0
    v_mov_b32 v27, 0
    v_mov_b32 v28, 0
    v_mov_b32 v29, 0
    v_mov_b32 v30, 0
    v_mov_b32 v31, 0
    v_mov_b32 v32, 0
    v_mov_b32 v33, 0
    v_mov_b32 v34, 0
    v_mov_b32 v35, 0
    v_mov_b32 v36, 0
    v_mov_b32 v37, 0
    v_mov_b32 v38, 0
    v_mov_b32 v39, 0
    s_lshl_b32 s72, s55, 12
    s_add_u32 s73, s58, s72
    v_lshl_add_u32 v5, v1, 4, s73
    s_xor_b32 s72, s72, 4096
    s_add_u32 s73, s58, s72
    v_lshl_add_u32 v168, v1, 4, s73
    v_lshlrev_b32 v4, 5, v2
    v_lshl_add_u32 v4, v3, 3, v4
    v_add_u32 v170, s73, v4
    s_add_u32 s73, s57, 504
    v_sub_u32 v169, s73, v4
    s_lshl_b32 s73, s54, 12
    s_lshl_b32 s72, s55, 11
    s_add_u32 s73, s73, s72
    s_add_u32 s73, s73, 9437184
    v_lshl_add_u32 v171, v1, 4, s73
    s_sub_u32 s71, s58, 140800
    s_lshr_b32 s71, s71, 10
    s_add_u32 s71, s71, 160560
    s_lshl_b32 s72, s55, 2
    s_add_u32 s73, s71, s72
    v_mov_b32 v172, s73
    s_xor_b32 s72, s72, 4
    s_add_u32 s73, s71, s72
    v_mov_b32 v173, s73
    s_and_b32 s74, s54, 1
    s_xor_b32 s74, s74, 1
    s_lshl_b32 s74, s74, 4
    s_lshl_b32 s53, s52, s74
    s_and_b32 s53, s53, 0xffff0000
    s_barrier
    s_cmp_eq_u32 s59, 0
    s_cbranch_scc1 L_conv_idle_55
    ds_read_b64 v[104:105], v6 offset:0
    ds_read_b64 v[106:107], v6 offset:8
    ds_read_b128 v[40:43], v7 offset:3584
    ds_read_b64 v[108:109], v6 offset:512
    ds_read_b64 v[110:111], v6 offset:520
    ds_read_b128 v[44:47], v7 offset:3072
    ds_read_b64 v[112:113], v6 offset:1024
    ds_read_b64 v[114:115], v6 offset:1032
    ds_read_b128 v[48:51], v7 offset:2560
    ds_read_b64 v[116:117], v6 offset:1536
    ds_read_b64 v[118:119], v6 offset:1544
    ds_read_b128 v[52:55], v7 offset:2048
    ds_read_b64 v[120:121], v6 offset:2048
    ds_read_b64 v[122:123], v6 offset:2056
    ds_read_b128 v[56:59], v7 offset:1536
    ds_read_b64 v[124:125], v6 offset:2560
    ds_read_b64 v[126:127], v6 offset:2568
    ds_read_b128 v[60:63], v7 offset:1024
    ds_read_b64 v[128:129], v6 offset:3072
    ds_read_b64 v[130:131], v6 offset:3080
    ds_read_b128 v[64:67], v7 offset:512
    ds_read_b64 v[132:133], v6 offset:3584
    ds_read_b64 v[134:135], v6 offset:3592
    ds_read_b128 v[68:71], v7 offset:0
    s_mov_b32 s70, 2
L_convl_57:
    s_waitcnt lgkmcnt(0)
    v_mfma_f32_16x16x32_bf16 v[8:11], v[104:107], v[40:43], v[8:11]
    ds_read_b64 v[136:137], v6 offset:64
    v_mfma_f32_16x16x32_bf16 v[12:15], v[104:107], v[44:47], v[12:15]
    ds_read_b64 v[138:139], v6 offset:72
    v_mfma_f32_16x16x32_bf16 v[16:19], v[104:107], v[48:51], v[16:19]
    ds_read_b128 v[72:75], v7 offset:3648
    v_mfma_f32_16x16x32_bf16 v[20:23], v[104:107], v[52:55], v[20:23]
    ds_read_b64 v[140:141], v6 offset:576
    v_mfma_f32_16x16x32_bf16 v[24:27], v[104:107], v[56:59], v[24:27]
    ds_read_b64 v[142:143], v6 offset:584
    v_mfma_f32_16x16x32_bf16 v[28:31], v[104:107], v[60:63], v[28:31]
    ds_read_b128 v[76:79], v7 offset:3136
    v_mfma_f32_16x16x32_bf16 v[32:35], v[104:107], v[64:67], v[32:35]
    ds_read_b64 v[144:145], v6 offset:1088
    v_mfma_f32_16x16x32_bf16 v[36:39], v[104:107], v[68:71], v[36:39]
    ds_read_b64 v[146:147], v6 offset:1096
    v_mfma_f32_16x16x32_bf16 v[12:15], v[108:111], v[40:43], v[12:15]
    ds_read_b128 v[80:83], v7 offset:2624
    v_mfma_f32_16x16x32_bf16 v[16:19], v[108:111], v[44:47], v[16:19]
    ds_read_b64 v[148:149], v6 offset:1600
    v_mfma_f32_16x16x32_bf16 v[20:23], v[108:111], v[48:51], v[20:23]
    ds_read_b64 v[150:151], v6 offset:1608
    v_mfma_f32_16x16x32_bf16 v[24:27], v[108:111], v[52:55], v[24:27]
    ds_read_b128 v[84:87], v7 offset:2112
    v_mfma_f32_16x16x32_bf16 v[28:31], v[108:111], v[56:59], v[28:31]
    ds_read_b64 v[152:153], v6 offset:2112
    v_mfma_f32_16x16x32_bf16 v[32:35], v[108:111], v[60:63], v[32:35]
    ds_read_b64 v[154:155], v6 offset:2120
    v_mfma_f32_16x16x32_bf16 v[36:39], v[108:111], v[64:67], v[36:39]
    ds_read_b128 v[88:91], v7 offset:1600
    v_mfma_f32_16x16x32_bf16 v[16:19], v[112:115], v[40:43], v[16:19]
    ds_read_b64 v[156:157], v6 offset:2624
    v_mfma_f32_16x16x32_bf16 v[20:23], v[112:115], v[44:47], v[20:23]
    ds_read_b64 v[158:159], v6 offset:2632
    v_mfma_f32_16x16x32_bf16 v[24:27], v[112:115], v[48:51], v[24:27]
    ds_read_b128 v[92:95], v7 offset:1088
    v_mfma_f32_16x16x32_bf16 v[28:31], v[112:115], v[52:55], v[28:31]
    ds_read_b64 v[160:161], v6 offset:3136
    v_mfma_f32_16x16x32_bf16 v[32:35], v[112:115], v[56:59], v[32:35]
    ds_read_b64 v[162:163], v6 offset:3144
    v_mfma_f32_16x16x32_bf16 v[36:39], v[112:115], v[60:63], v[36:39]
    ds_read_b128 v[96:99], v7 offset:576
    v_mfma_f32_16x16x32_bf16 v[20:23], v[116:119], v[40:43], v[20:23]
    ds_read_b64 v[164:165], v6 offset:3648
    v_mfma_f32_16x16x32_bf16 v[24:27], v[116:119], v[44:47], v[24:27]
    ds_read_b64 v[166:167], v6 offset:3656
    v_mfma_f32_16x16x32_bf16 v[28:31], v[116:119], v[48:51], v[28:31]
    ds_read_b128 v[100:103], v7 offset:64
    v_mfma_f32_16x16x32_bf16 v[32:35], v[116:119], v[52:55], v[32:35]
    v_mfma_f32_16x16x32_bf16 v[36:39], v[116:119], v[56:59], v[36:39]
    v_mfma_f32_16x16x32_bf16 v[24:27], v[120:123], v[40:43], v[24:27]
    v_mfma_f32_16x16x32_bf16 v[28:31], v[120:123], v[44:47], v[28:31]
    v_mfma_f32_16x16x32_bf16 v[32:35], v[120:123], v[48:51], v[32:35]
    v_mfma_f32_16x16x32_bf16 v[36:39], v[120:123], v[52:55], v[36:39]
    v_mfma_f32_16x16x32_bf16 v[28:31], v[124:127], v[40:43], v[28:31]
    v_mfma_f32_16x16x32_bf16 v[32:35], v[124:127], v[44:47], v[32:35]
    v_mfma_f32_16x16x32_bf16 v[36:39], v[124:127], v[48:51], v[36:39]
    v_mfma_f32_16x16x32_bf16 v[32:35], v[128:131], v[40:43], v[32:35]
    v_mfma_f32_16x16x32_bf16 v[36:39], v[128:131], v[44:47], v[36:39]
    v_mfma_f32_16x16x32_bf16 v[36:39], v[132:135], v[40:43], v[36:39]
    s_waitcnt lgkmcnt(0)
    v_mfma_f32_16x16x32_bf16 v[8:11], v[136:139], v[72:75], v[8:11]
    ds_read_b64 v[104:105], v6 offset:128
    v_mfma_f32_16x16x32_bf16 v[12:15], v[136:139], v[76:79], v[12:15]
    ds_read_b64 v[106:107], v6 offset:136
    v_mfma_f32_16x16x32_bf16 v[16:19], v[136:139], v[80:83], v[16:19]
    ds_read_b128 v[40:43], v7 offset:3712
    v_mfma_f32_16x16x32_bf16 v[20:23], v[136:139], v[84:87], v[20:23]
    ds_read_b64 v[108:109], v6 offset:640
    v_mfma_f32_16x16x32_bf16 v[24:27], v[136:139], v[88:91], v[24:27]
    ds_read_b64 v[110:111], v6 offset:648
    v_mfma_f32_16x16x32_bf16 v[28:31], v[136:139], v[92:95], v[28:31]
    ds_read_b128 v[44:47], v7 offset:3200
    v_mfma_f32_16x16x32_bf16 v[32:35], v[136:139], v[96:99], v[32:35]
    ds_read_b64 v[112:113], v6 offset:1152
    v_mfma_f32_16x16x32_bf16 v[36:39], v[136:139], v[100:103], v[36:39]
    ds_read_b64 v[114:115], v6 offset:1160
    v_mfma_f32_16x16x32_bf16 v[12:15], v[140:143], v[72:75], v[12:15]
    ds_read_b128 v[48:51], v7 offset:2688
    v_mfma_f32_16x16x32_bf16 v[16:19], v[140:143], v[76:79], v[16:19]
    ds_read_b64 v[116:117], v6 offset:1664
    v_mfma_f32_16x16x32_bf16 v[20:23], v[140:143], v[80:83], v[20:23]
    ds_read_b64 v[118:119], v6 offset:1672
    v_mfma_f32_16x16x32_bf16 v[24:27], v[140:143], v[84:87], v[24:27]
    ds_read_b128 v[52:55], v7 offset:2176
    v_mfma_f32_16x16x32_bf16 v[28:31], v[140:143], v[88:91], v[28:31]
    ds_read_b64 v[120:121], v6 offset:2176
    v_mfma_f32_16x16x32_bf16 v[32:35], v[140:143], v[92:95], v[32:35]
    ds_read_b64 v[122:123], v6 offset:2184
    v_mfma_f32_16x16x32_bf16 v[36:39], v[140:143], v[96:99], v[36:39]
    ds_read_b128 v[56:59], v7 offset:1664
    v_mfma_f32_16x16x32_bf16 v[16:19], v[144:147], v[72:75], v[16:19]
    ds_read_b64 v[124:125], v6 offset:2688
    v_mfma_f32_16x16x32_bf16 v[20:23], v[144:147], v[76:79], v[20:23]
    ds_read_b64 v[126:127], v6 offset:2696
    v_mfma_f32_16x16x32_bf16 v[24:27], v[144:147], v[80:83], v[24:27]
    ds_read_b128 v[60:63], v7 offset:1152
    v_mfma_f32_16x16x32_bf16 v[28:31], v[144:147], v[84:87], v[28:31]
    ds_read_b64 v[128:129], v6 offset:3200
    v_mfma_f32_16x16x32_bf16 v[32:35], v[144:147], v[88:91], v[32:35]
    ds_read_b64 v[130:131], v6 offset:3208
    v_mfma_f32_16x16x32_bf16 v[36:39], v[144:147], v[92:95], v[36:39]
    ds_read_b128 v[64:67], v7 offset:640
    v_mfma_f32_16x16x32_bf16 v[20:23], v[148:151], v[72:75], v[20:23]
    ds_read_b64 v[132:133], v6 offset:3712
    v_mfma_f32_16x16x32_bf16 v[24:27], v[148:151], v[76:79], v[24:27]
    ds_read_b64 v[134:135], v6 offset:3720
    v_mfma_f32_16x16x32_bf16 v[28:31], v[148:151], v[80:83], v[28:31]
    ds_read_b128 v[68:71], v7 offset:128
    v_mfma_f32_16x16x32_bf16 v[32:35], v[148:151], v[84:87], v[32:35]
    v_mfma_f32_16x16x32_bf16 v[36:39], v[148:151], v[88:91], v[36:39]
    v_mfma_f32_16x16x32_bf16 v[24:27], v[152:155], v[72:75], v[24:27]
    v_mfma_f32_16x16x32_bf16 v[28:31], v[152:155], v[76:79], v[28:31]
    v_mfma_f32_16x16x32_bf16 v[32:35], v[152:155], v[80:83], v[32:35]
    v_mfma_f32_16x16x32_bf16 v[36:39], v[152:155], v[84:87], v[36:39]
    v_mfma_f32_16x16x32_bf16 v[28:31], v[156:159], v[72:75], v[28:31]
    v_mfma_f32_16x16x32_bf16 v[32:35], v[156:159], v[76:79], v[32:35]
    v_mfma_f32_16x16x32_bf16 v[36:39], v[156:159], v[80:83], v[36:39]
    v_mfma_f32_16x16x32_bf16 v[32:35], v[160:163], v[72:75], v[32:35]
    v_mfma_f32_16x16x32_bf16 v[36:39], v[160:163], v[76:79], v[36:39]
    v_mfma_f32_16x16x32_bf16 v[36:39], v[164:167], v[72:75], v[36:39]
    v_add_u32 v6, 128, v6
    v_add_u32 v7, 128, v7
    s_sub_u32 s70, s70, 1
    s_cmp_lg_u32 s70, 0
    s_cbranch_scc1 L_convl_57
    s_cmp_eq_u32 s55, 1
    s_cbranch_scc1 L_fin1_58
    ds_read_b64 v[72:73], v169 offset:3584
    ds_read_b64 v[74:75], v169 offset:3072
    ds_read_b64 v[76:77], v169 offset:2560
    ds_read_b64 v[78:79], v169 offset:2048
    ds_write_b128 v5, v[24:27] offset:0
    ds_write_b128 v5, v[28:31] offset:1024
    ds_write_b128 v5, v[32:35] offset:2048
    ds_write_b128 v5, v[36:39] offset:3072
    v_mov_b32 v251, 1
    s_waitcnt lgkmcnt(0)
    ds_write_b32 v172, v251
    s_mov_b32 s74, 0
L_zf_59:
    ds_read_b32 v251, v173
    s_waitcnt lgkmcnt(0)
    v_readfirstlane_b32 s75, v251
    s_add_u32 s74, s74, 1
    s_nop 2
    s_cmp_eq_u32 s75, 1
    s_cbranch_scc1 L_zfx_60
    s_cmp_ge_u32 s74, 1048576
    s_cbranch_scc1 L_zfx_60
    s_branch L_zf_59
L_zfx_60:
    ds_read_b128 v[40:43], v168 offset:0
    ds_read_b128 v[44:47], v168 offset:1024
    ds_read_b128 v[48:51], v168 offset:2048
    ds_read_b128 v[52:55], v168 offset:3072
    v_and_b32 v100, 0xffff0000, v73
    v_lshlrev_b32 v101, 16, v73
    v_and_b32 v102, 0xffff0000, v72
    v_lshlrev_b32 v103, 16, v72
    v_fmac_f32 v8, s53, v100
    v_fmac_f32 v9, s53, v101
    v_fmac_f32 v10, s53, v102
    v_fmac_f32 v11, s53, v103
    v_and_b32 v100, 0xffff0000, v75
    v_lshlrev_b32 v101, 16, v75
    v_and_b32 v102, 0xffff0000, v74
    v_lshlrev_b32 v103, 16, v74
    v_fmac_f32 v12, s53, v100
    v_fmac_f32 v13, s53, v101
    v_fmac_f32 v14, s53, v102
    v_fmac_f32 v15, s53, v103
    v_and_b32 v100, 0xffff0000, v77
    v_lshlrev_b32 v101, 16, v77
    v_and_b32 v102, 0xffff0000, v76
    v_lshlrev_b32 v103, 16, v76
    v_fmac_f32 v16, s53, v100
    v_fmac_f32 v17, s53, v101
    v_fmac_f32 v18, s53, v102
    v_fmac_f32 v19, s53, v103
    v_and_b32 v100, 0xffff0000, v79
    v_lshlrev_b32 v101, 16, v79
    v_and_b32 v102, 0xffff0000, v78
    v_lshlrev_b32 v103, 16, v78
    v_fmac_f32 v20, s53, v100
    v_fmac_f32 v21, s53, v101
    v_fmac_f32 v22, s53, v102
    v_fmac_f32 v23, s53, v103
    s_waitcnt lgkmcnt(0)
    v_add_f32 v8, v8, v40
    v_add_f32 v9, v9, v41
    v_add_f32 v10, v10, v42
    v_add_f32 v11, v11, v43
    v_add_f32 v12, v12, v44
    v_add_f32 v13, v13, v45
    v_add_f32 v14, v14, v46
    v_add_f32 v15, v15, v47
    v_add_f32 v16, v16, v48
    v_add_f32 v17, v17, v49
    v_add_f32 v18, v18, v50
    v_add_f32 v19, v19, v51
    v_add_f32 v20, v20, v52
    v_add_f32 v21, v21, v53
    v_add_f32 v22, v22, v54
    v_add_f32 v23, v23, v55
    v_cvt_pk_bf16_f32 v104, v8, v9
    v_cvt_pk_bf16_f32 v105, v10, v11
    ds_write_b64 v170, v[104:105] offset:0
    v_cvt_pk_bf16_f32 v106, v12, v13
    v_cvt_pk_bf16_f32 v107, v14, v15
    ds_write_b64 v170, v[106:107] offset:512
    v_cvt_pk_bf16_f32 v108, v16, v17
    v_cvt_pk_bf16_f32 v109, v18, v19
    ds_write_b64 v170, v[108:109] offset:1024
    v_cvt_pk_bf16_f32 v110, v20, v21
    v_cvt_pk_bf16_f32 v111, v22, v23
    ds_write_b64 v170, v[110:111] offset:1536
    s_waitcnt lgkmcnt(0)
    ds_read_b128 v[40:43], v168 offset:0
    ds_read_b128 v[44:47], v168 offset:1024
    s_waitcnt lgkmcnt(0)
    buffer_store_dwordx4 v[40:43], v171, s[4:7], 0 offen offset:0 sc1
    buffer_store_dwordx4 v[44:47], v171, s[4:7], 0 offen offset:1024 sc1
    s_branch L_conv_idle_55
L_fin1_58:
    ds_read_b64 v[72:73], v169 offset:1536
    ds_read_b64 v[74:75], v169 offset:1024
    ds_read_b64 v[76:77], v169 offset:512
    ds_read_b64 v[78:79], v169 offset:0
    ds_write_b128 v5, v[8:11] offset:0
    ds_write_b128 v5, v[12:15] offset:1024
    ds_write_b128 v5, v[16:19] offset:2048
    ds_write_b128 v5, v[20:23] offset:3072
    v_mov_b32 v251, 1
    s_waitcnt lgkmcnt(0)
    ds_write_b32 v172, v251
    s_mov_b32 s74, 0
L_zf_61:
    ds_read_b32 v251, v173
    s_waitcnt lgkmcnt(0)
    v_readfirstlane_b32 s75, v251
    s_add_u32 s74, s74, 1
    s_nop 2
    s_cmp_eq_u32 s75, 1
    s_cbranch_scc1 L_zfx_62
    s_cmp_ge_u32 s74, 1048576
    s_cbranch_scc1 L_zfx_62
    s_branch L_zf_61
L_zfx_62:
    ds_read_b128 v[40:43], v168 offset:0
    ds_read_b128 v[44:47], v168 offset:1024
    ds_read_b128 v[48:51], v168 offset:2048
    ds_read_b128 v[52:55], v168 offset:3072
    v_and_b32 v100, 0xffff0000, v73
    v_lshlrev_b32 v101, 16, v73
    v_and_b32 v102, 0xffff0000, v72
    v_lshlrev_b32 v103, 16, v72
    v_fmac_f32 v24, s53, v100
    v_fmac_f32 v25, s53, v101
    v_fmac_f32 v26, s53, v102
    v_fmac_f32 v27, s53, v103
    v_and_b32 v100, 0xffff0000, v75
    v_lshlrev_b32 v101, 16, v75
    v_and_b32 v102, 0xffff0000, v74
    v_lshlrev_b32 v103, 16, v74
    v_fmac_f32 v28, s53, v100
    v_fmac_f32 v29, s53, v101
    v_fmac_f32 v30, s53, v102
    v_fmac_f32 v31, s53, v103
    v_and_b32 v100, 0xffff0000, v77
    v_lshlrev_b32 v101, 16, v77
    v_and_b32 v102, 0xffff0000, v76
    v_lshlrev_b32 v103, 16, v76
    v_fmac_f32 v32, s53, v100
    v_fmac_f32 v33, s53, v101
    v_fmac_f32 v34, s53, v102
    v_fmac_f32 v35, s53, v103
    v_and_b32 v100, 0xffff0000, v79
    v_lshlrev_b32 v101, 16, v79
    v_and_b32 v102, 0xffff0000, v78
    v_lshlrev_b32 v103, 16, v78
    v_fmac_f32 v36, s53, v100
    v_fmac_f32 v37, s53, v101
    v_fmac_f32 v38, s53, v102
    v_fmac_f32 v39, s53, v103
    s_waitcnt lgkmcnt(0)
    v_add_f32 v24, v24, v40
    v_add_f32 v25, v25, v41
    v_add_f32 v26, v26, v42
    v_add_f32 v27, v27, v43
    v_add_f32 v28, v28, v44
    v_add_f32 v29, v29, v45
    v_add_f32 v30, v30, v46
    v_add_f32 v31, v31, v47
    v_add_f32 v32, v32, v48
    v_add_f32 v33, v33, v49
    v_add_f32 v34, v34, v50
    v_add_f32 v35, v35, v51
    v_add_f32 v36, v36, v52
    v_add_f32 v37, v37, v53
    v_add_f32 v38, v38, v54
    v_add_f32 v39, v39, v55
    v_cvt_pk_bf16_f32 v104, v24, v25
    v_cvt_pk_bf16_f32 v105, v26, v27
    ds_write_b64 v170, v[104:105] offset:0
    v_cvt_pk_bf16_f32 v106, v28, v29
    v_cvt_pk_bf16_f32 v107, v30, v31
    ds_write_b64 v170, v[106:107] offset:512
    v_cvt_pk_bf16_f32 v108, v32, v33
    v_cvt_pk_bf16_f32 v109, v34, v35
    ds_write_b64 v170, v[108:109] offset:1024
    v_cvt_pk_bf16_f32 v110, v36, v37
    v_cvt_pk_bf16_f32 v111, v38, v39
    ds_write_b64 v170, v[110:111] offset:1536
    s_waitcnt lgkmcnt(0)
    ds_read_b128 v[40:43], v168 offset:0
    ds_read_b128 v[44:47], v168 offset:1024
    s_waitcnt lgkmcnt(0)
    buffer_store_dwordx4 v[40:43], v171, s[4:7], 0 offen offset:0 sc1
    buffer_store_dwordx4 v[44:47], v171, s[4:7], 0 offen offset:1024 sc1
L_conv_idle_55:
L_cv2_5:
    s_waitcnt lgkmcnt(0)
    s_barrier
L_att_6:
    s_mul_hi_u32 s67, s48, 0x24924925
    s_mul_i32 s68, s67, 7
    s_sub_u32 s65, s48, s68
    s_lshl_b32 s67, s67, 3
    s_add_u32 s64, s67, s49
    s_cmp_lt_u32 s48, 28
    s_cselect_b32 s66, 1, 0
    s_lshr_b32 s53, s3, 2
    s_and_b32 s55, s3, 3
    s_lshl_b32 s56, s50, 6
    s_lshl_b32 s57, s53, 5
    s_add_u32 s56, s56, s57
    s_add_u32 s56, s56, s55
    s_lshl_b32 s56, s56, 12
    s_add_u32 s56, s56, 0
    v_lshl_add_u32 v200, v1, 4, s56
    s_lshl_b32 s57, s3, 12
    s_bfe_u32 s69, s3, 0x10001
    s_and_b32 s70, s3, 1
    s_lshl_b32 s70, s70, 1
    s_add_u32 s71, s70, s69
    s_xor_b32 s72, s71, 1
    s_mov_b32 s56, s71
    s_lshl_b32 s73, s71, 11
    s_add_u32 s73, s73, 65536
    v_lshl_add_u32 v201, v1, 4, s73
    s_lshl_b32 s73, s72, 11
    s_add_u32 s73, s73, 65536
    v_lshl_add_u32 v202, v1, 4, s73
    ds_read_b128 v[204:207], v201
    ds_read_b128 v[208:211], v201 offset:1024
    ds_read_b128 v[212:215], v202
    ds_read_b128 v[216:219], v202 offset:1024
    s_lshl_b32 s73, s71, 8
    s_add_u32 s73, s73, 74240
    v_lshl_add_u32 v12, v1, 2, s73
    ds_read_b32 v8, v12
    s_lshl_b32 s73, s72, 8
    s_add_u32 s73, s73, 74240
    v_lshl_add_u32 v12, v1, 2, s73
    ds_read_b32 v9, v12
    v_mov_b32 v10, 160512
    ds_read_b128 v[12:15], v10
    s_lshl_b32 s73, s69, 14
    v_lshl_add_u32 v198, v1, 4, s73
    v_add_u32 v199, 65536, v198
    s_waitcnt lgkmcnt(0)
    s_barrier
    v_or_b32 v12, v12, v13
    v_or_b32 v12, v12, v14
    v_or_b32 v12, v12, v15
    s_nop 0
    v_readfirstlane_b32 s67, v12
    s_nop 3
    s_cmp_eq_u32 s67, 0
    s_cbranch_scc1 L_fast_65
    v_mov_b32 v8, 0xff800000
    v_mov_b32 v9, 0xff800000
    s_mov_b32 s68, 0
L_maxloop_66:
    s_add_u32 m0, s57, 65536
    s_add_u32 s58, s68, 0
    buffer_load_dwordx4 v200, s[4:7], s58 offen sc1 lds
    s_add_u32 m0, s57, 66560
    s_add_u32 s58, s68, 1024
    buffer_load_dwordx4 v200, s[4:7], s58 offen sc1 lds
    s_waitcnt vmcnt(0)
    s_barrier
    s_cmp_ge_u32 s3, 4
    s_cbranch_scc1 L_nomax_67
    ds_read_b128 v[40:43], v199 offset:0
    ds_read_b128 v[44:47], v199 offset:1024
    s_waitcnt lgkmcnt(0)
    v_mfma_f32_32x32x16_bf16 v[48:63], v[40:43], v[204:207], 0
    v_mfma_f32_32x32x16_bf16 v[48:63], v[44:47], v[208:211], v[48:63]
    v_mfma_f32_32x32x16_bf16 v[64:79], v[40:43], v[212:215], 0
    v_mfma_f32_32x32x16_bf16 v[64:79], v[44:47], v[216:219], v[64:79]
    s_nop 9
    v_max_f32 v8, v8, v48
    v_max_f32 v8, v8, v49
    v_max_f32 v8, v8, v50
    v_max_f32 v8, v8, v51
    v_max_f32 v8, v8, v52
    v_max_f32 v8, v8, v53
    v_max_f32 v8, v8, v54
    v_max_f32 v8, v8, v55
    v_max_f32 v8, v8, v56
    v_max_f32 v8, v8, v57
    v_max_f32 v8, v8, v58
    v_max_f32 v8, v8, v59
    v_max_f32 v8, v8, v60
    v_max_f32 v8, v8, v61
    v_max_f32 v8, v8, v62
    v_max_f32 v8, v8, v63
    v_max_f32 v9, v9, v64
    v_max_f32 v9, v9, v65
    v_max_f32 v9, v9, v66
    v_max_f32 v9, v9, v67
    v_max_f32 v9, v9, v68
    v_max_f32 v9, v9, v69
    v_max_f32 v9, v9, v70
    v_max_f32 v9, v9, v71
    v_max_f32 v9, v9, v72
    v_max_f32 v9, v9, v73
    v_max_f32 v9, v9, v74
    v_max_f32 v9, v9, v75
    v_max_f32 v9, v9, v76
    v_max_f32 v9, v9, v77
    v_max_f32 v9, v9, v78
    v_max_f32 v9, v9, v79
    ds_read_b128 v[40:43], v199 offset:4096
    ds_read_b128 v[44:47], v199 offset:5120
    s_waitcnt lgkmcnt(0)
    v_mfma_f32_32x32x16_bf16 v[48:63], v[40:43], v[204:207], 0
    v_mfma_f32_32x32x16_bf16 v[48:63], v[44:47], v[208:211], v[48:63]
    v_mfma_f32_32x32x16_bf16 v[64:79], v[40:43], v[212:215], 0
    v_mfma_f32_32x32x16_bf16 v[64:79], v[44:47], v[216:219], v[64:79]
    s_nop 9
    v_max_f32 v8, v8, v48
    v_max_f32 v8, v8, v49
    v_max_f32 v8, v8, v50
    v_max_f32 v8, v8, v51
    v_max_f32 v8, v8, v52
    v_max_f32 v8, v8, v53
    v_max_f32 v8, v8, v54
    v_max_f32 v8, v8, v55
    v_max_f32 v8, v8, v56
    v_max_f32 v8, v8, v57
    v_max_f32 v8, v8, v58
    v_max_f32 v8, v8, v59
    v_max_f32 v8, v8, v60
    v_max_f32 v8, v8, v61
    v_max_f32 v8, v8, v62
    v_max_f32 v8, v8, v63
    v_max_f32 v9, v9, v64
    v_max_f32 v9, v9, v65
    v_max_f32 v9, v9, v66
    v_max_f32 v9, v9, v67
    v_max_f32 v9, v9, v68
    v_max_f32 v9, v9, v69
    v_max_f32 v9, v9, v70
    v_max_f32 v9, v9, v71
    v_max_f32 v9, v9, v72
    v_max_f32 v9, v9, v73
    v_max_f32 v9, v9, v74
    v_max_f32 v9, v9, v75
    v_max_f32 v9, v9, v76
    v_max_f32 v9, v9, v77
    v_max_f32 v9, v9, v78
    v_max_f32 v9, v9, v79
    ds_read_b128 v[40:43], v199 offset:8192
    ds_read_b128 v[44:47], v199 offset:9216
    s_waitcnt lgkmcnt(0)
    v_mfma_f32_32x32x16_bf16 v[48:63], v[40:43], v[204:207], 0
    v_mfma_f32_32x32x16_bf16 v[48:63], v[44:47], v[208:211], v[48:63]
    v_mfma_f32_32x32x16_bf16 v[64:79], v[40:43], v[212:215], 0
    v_mfma_f32_32x32x16_bf16 v[64:79], v[44:47], v[216:219], v[64:79]
    s_nop 9
    v_max_f32 v8, v8, v48
    v_max_f32 v8, v8, v49
    v_max_f32 v8, v8, v50
    v_max_f32 v8, v8, v51
    v_max_f32 v8, v8, v52
    v_max_f32 v8, v8, v53
    v_max_f32 v8, v8, v54
    v_max_f32 v8, v8, v55
    v_max_f32 v8, v8, v56
    v_max_f32 v8, v8, v57
    v_max_f32 v8, v8, v58
    v_max_f32 v8, v8, v59
    v_max_f32 v8, v8, v60
    v_max_f32 v8, v8, v61
    v_max_f32 v8, v8, v62
    v_max_f32 v8, v8, v63
    v_max_f32 v9, v9, v64
    v_max_f32 v9, v9, v65
    v_max_f32 v9, v9, v66
    v_max_f32 v9, v9, v67
    v_max_f32 v9, v9, v68
    v_max_f32 v9, v9, v69
    v_max_f32 v9, v9, v70
    v_max_f32 v9, v9, v71
    v_max_f32 v9, v9, v72
    v_max_f32 v9, v9, v73
    v_max_f32 v9, v9, v74
    v_max_f32 v9, v9, v75
    v_max_f32 v9, v9, v76
    v_max_f32 v9, v9, v77
    v_max_f32 v9, v9, v78
    v_max_f32 v9, v9, v79
    ds_read_b128 v[40:43], v199 offset:12288
    ds_read_b128 v[44:47], v199 offset:13312
    s_waitcnt lgkmcnt(0)
    v_mfma_f32_32x32x16_bf16 v[48:63], v[40:43], v[204:207], 0
    v_mfma_f32_32x32x16_bf16 v[48:63], v[44:47], v[208:211], v[48:63]
    v_mfma_f32_32x32x16_bf16 v[64:79], v[40:43], v[212:215], 0
    v_mfma_f32_32x32x16_bf16 v[64:79], v[44:47], v[216:219], v[64:79]
    s_nop 9
    v_max_f32 v8, v8, v48
    v_max_f32 v8, v8, v49
    v_max_f32 v8, v8, v50
    v_max_f32 v8, v8, v51
    v_max_f32 v8, v8, v52
    v_max_f32 v8, v8, v53
    v_max_f32 v8, v8, v54
    v_max_f32 v8, v8, v55
    v_max_f32 v8, v8, v56
    v_max_f32 v8, v8, v57
    v_max_f32 v8, v8, v58
    v_max_f32 v8, v8, v59
    v_max_f32 v8, v8, v60
    v_max_f32 v8, v8, v61
    v_max_f32 v8, v8, v62
    v_max_f32 v8, v8, v63
    v_max_f32 v9, v9, v64
    v_max_f32 v9, v9, v65
    v_max_f32 v9, v9, v66
    v_max_f32 v9, v9, v67
    v_max_f32 v9, v9, v68
    v_max_f32 v9, v9, v69
    v_max_f32 v9, v9, v70
    v_max_f32 v9, v9, v71
    v_max_f32 v9, v9, v72
    v_max_f32 v9, v9, v73
    v_max_f32 v9, v9, v74
    v_max_f32 v9, v9, v75
    v_max_f32 v9, v9, v76
    v_max_f32 v9, v9, v77
    v_max_f32 v9, v9, v78
    v_max_f32 v9, v9, v79
L_nomax_67:
    s_barrier
    s_add_u32 s68, s68, 16384
    s_cmp_lt_u32 s68, 131072
    s_cbranch_scc1 L_maxloop_66
    v_mov_b32 v10, v8
    s_nop 1
    v_permlane32_swap_b32 v8, v10
    v_max_f32 v8, v8, v10
    v_mov_b32 v10, v9
    s_nop 1
    v_permlane32_swap_b32 v9, v10
    v_max_f32 v9, v9, v10
    s_lshl_b32 s68, s3, 9
    s_add_u32 s68, s68, 65536
    v_lshl_add_u32 v12, v1, 2, s68
    ds_write_b32 v12, v8
    ds_write_b32 v12, v9 offset:256
    s_waitcnt lgkmcnt(0)
    s_barrier
    s_xor_b32 s68, s3, 2
    s_lshl_b32 s68, s68, 9
    s_add_u32 s68, s68, 65536
    v_lshl_add_u32 v12, v1, 2, s68
    ds_read_b32 v13, v12 offset:256
    ds_read_b32 v14, v12
    s_waitcnt lgkmcnt(0)
    v_max_f32 v8, v8, v13
    v_max_f32 v9, v9, v14
    s_barrier
L_fast_65:
    s_cmp_ge_u32 s3, 4
    s_cbranch_scc1 L_loader_63
    s_mov_b32 s62, 0
    s_mov_b32 s63, -1
    ds_read_b128 v[144:147], v198 offset:0
    ds_read_b128 v[148:151], v198 offset:1024
    ds_read_b128 v[152:155], v198 offset:4096
    ds_read_b128 v[156:159], v198 offset:5120
    ds_read_b128 v[160:163], v198 offset:2048
    v_and_b32 v12, 0xffff0000, v8
    v_sub_f32 v13, v8, v12
    v_and_b32 v14, 0xffff0000, v13
    v_sub_f32 v13, v13, v14
    v_and_b32 v15, 0xffff0000, v13
    v_xor_b32 v12, 0x80000000, v12
    v_xor_b32 v14, 0x80000000, v14
    v_xor_b32 v15, 0x80000000, v15
    v_lshrrev_b32 v12, 16, v12
    v_or_b32 v12, v12, v14
    v_lshrrev_b32 v15, 16, v15
    v_cndmask_b32 v210, v210, v12, s[62:63]
    v_cndmask_b32 v211, v211, v15, s[62:63]
    v_and_b32 v12, 0xffff0000, v9
    v_sub_f32 v13, v9, v12
    v_and_b32 v14, 0xffff0000, v13
    v_sub_f32 v13, v13, v14
    v_and_b32 v15, 0xffff0000, v13
    v_xor_b32 v12, 0x80000000, v12
    v_xor_b32 v14, 0x80000000, v14
    v_xor_b32 v15, 0x80000000, v15
    v_lshrrev_b32 v12, 16, v12
    v_or_b32 v12, v12, v14
    v_lshrrev_b32 v15, 16, v15
    v_cndmask_b32 v218, v218, v12, s[62:63]
    v_cndmask_b32 v219, v219, v15, s[62:63]
    s_waitcnt lgkmcnt(3)
    v_mfma_f32_32x32x16_bf16 v[32:47], v[144:147], v[204:207], 0
    v_mfma_f32_32x32x16_bf16 v[64:79], v[144:147], v[212:215], 0
    v_mfma_f32_32x32x16_bf16 v[32:47], v[148:151], v[208:211], v[32:47]
    v_mfma_f32_32x32x16_bf16 v[64:79], v[148:151], v[216:219], v[64:79]
    s_waitcnt lgkmcnt(0)
    v_mfma_f32_32x32x16_bf16 v[48:63], v[152:155], v[204:207], 0
    s_nop 8
    v_exp_f32 v32, v32
    v_exp_f32 v33, v33
    v_exp_f32 v34, v34
    v_exp_f32 v35, v35
    v_cvt_pk_bf16_f32 v96, v32, v33
    v_cvt_pk_bf16_f32 v97, v34, v35
    v_exp_f32 v36, v36
    v_exp_f32 v37, v37
    v_exp_f32 v38, v38
    v_exp_f32 v39, v39
    v_cvt_pk_bf16_f32 v98, v36, v37
    v_cvt_pk_bf16_f32 v99, v38, v39
    v_mfma_f32_32x32x16_bf16 v[48:63], v[156:159], v[208:211], v[48:63]
    ds_read_b128 v[144:147], v198 offset:8192
    ds_read_b128 v[148:151], v198 offset:9216
    ds_read_b128 v[164:167], v198 offset:6144
    ds_read_b128 v[168:171], v198 offset:3072
    v_exp_f32 v40, v40
    v_exp_f32 v41, v41
    v_exp_f32 v42, v42
    v_exp_f32 v43, v43
    v_cvt_pk_bf16_f32 v100, v40, v41
    v_cvt_pk_bf16_f32 v101, v42, v43
    v_mfma_f32_32x32x16_bf16 v[112:127], v[160:163], v[96:99], 0
    v_exp_f32 v44, v44
    v_exp_f32 v45, v45
    v_exp_f32 v46, v46
    v_exp_f32 v47, v47
    v_mfma_f32_32x32x16_bf16 v[80:95], v[152:155], v[212:215], 0
    v_exp_f32 v64, v64
    v_exp_f32 v65, v65
    v_exp_f32 v66, v66
    v_exp_f32 v67, v67
    v_cvt_pk_bf16_f32 v104, v64, v65
    v_cvt_pk_bf16_f32 v105, v66, v67
    v_exp_f32 v68, v68
    v_exp_f32 v69, v69
    v_exp_f32 v70, v70
    v_exp_f32 v71, v71
    v_cvt_pk_bf16_f32 v106, v68, v69
    v_cvt_pk_bf16_f32 v107, v70, v71
    v_mfma_f32_32x32x16_bf16 v[80:95], v[156:159], v[216:219], v[80:95]
    v_exp_f32 v72, v72
    v_exp_f32 v73, v73
    v_exp_f32 v74, v74
    v_exp_f32 v75, v75
    v_cvt_pk_bf16_f32 v108, v72, v73
    v_cvt_pk_bf16_f32 v109, v74, v75
    v_mfma_f32_32x32x16_bf16 v[128:143], v[160:163], v[104:107], 0
    v_exp_f32 v76, v76
    v_exp_f32 v77, v77
    v_exp_f32 v78, v78
    v_exp_f32 v79, v79
    v_cvt_pk_bf16_f32 v102, v44, v45
    v_cvt_pk_bf16_f32 v103, v46, v47
    s_waitcnt lgkmcnt(0)
    v_mfma_f32_32x32x16_bf16 v[32:47], v[144:147], v[204:207], 0
    v_exp_f32 v48, v48
    v_exp_f32 v49, v49
    v_exp_f32 v50, v50
    v_exp_f32 v51, v51
    v_cvt_pk_bf16_f32 v96, v48, v49
    v_cvt_pk_bf16_f32 v97, v50, v51
    v_mfma_f32_32x32x16_bf16 v[112:127], v[168:171], v[100:103], v[112:127]
    v_exp_f32 v52, v52
    v_exp_f32 v53, v53
    v_exp_f32 v54, v54
    v_exp_f32 v55, v55
    v_cvt_pk_bf16_f32 v98, v52, v53
    v_cvt_pk_bf16_f32 v99, v54, v55
    v_mfma_f32_32x32x16_bf16 v[32:47], v[148:151], v[208:211], v[32:47]
    ds_read_b128 v[152:155], v198 offset:12288
    ds_read_b128 v[156:159], v198 offset:13312
    ds_read_b128 v[160:163], v198 offset:10240
    ds_read_b128 v[172:175], v198 offset:7168
    v_exp_f32 v56, v56
    v_exp_f32 v57, v57
    v_exp_f32 v58, v58
    v_exp_f32 v59, v59
    v_cvt_pk_bf16_f32 v100, v56, v57
    v_cvt_pk_bf16_f32 v101, v58, v59
    v_mfma_f32_32x32x16_bf16 v[112:127], v[164:167], v[96:99], v[112:127]
    v_exp_f32 v60, v60
    v_exp_f32 v61, v61
    v_exp_f32 v62, v62
    v_exp_f32 v63, v63
    v_cvt_pk_bf16_f32 v110, v76, v77
    v_cvt_pk_bf16_f32 v111, v78, v79
    v_mfma_f32_32x32x16_bf16 v[64:79], v[144:147], v[212:215], 0
    v_exp_f32 v80, v80
    v_exp_f32 v81, v81
    v_exp_f32 v82, v82
    v_exp_f32 v83, v83
    v_cvt_pk_bf16_f32 v104, v80, v81
    v_cvt_pk_bf16_f32 v105, v82, v83
    v_mfma_f32_32x32x16_bf16 v[128:143], v[168:171], v[108:111], v[128:143]
    v_exp_f32 v84, v84
    v_exp_f32 v85, v85
    v_exp_f32 v86, v86
    v_exp_f32 v87, v87
    v_cvt_pk_bf16_f32 v106, v84, v85
    v_cvt_pk_bf16_f32 v107, v86, v87
    v_mfma_f32_32x32x16_bf16 v[64:79], v[148:151], v[216:219], v[64:79]
    v_exp_f32 v88, v88
    v_exp_f32 v89, v89
    v_exp_f32 v90, v90
    v_exp_f32 v91, v91
    v_cvt_pk_bf16_f32 v108, v88, v89
    v_cvt_pk_bf16_f32 v109, v90, v91
    v_mfma_f32_32x32x16_bf16 v[128:143], v[164:167], v[104:107], v[128:143]
    v_exp_f32 v92, v92
    v_exp_f32 v93, v93
    v_exp_f32 v94, v94
    v_exp_f32 v95, v95
    v_cvt_pk_bf16_f32 v102, v60, v61
    v_cvt_pk_bf16_f32 v103, v62, v63
    s_waitcnt lgkmcnt(0)
    v_mfma_f32_32x32x16_bf16 v[48:63], v[152:155], v[204:207], 0
    v_exp_f32 v32, v32
    v_exp_f32 v33, v33
    v_exp_f32 v34, v34
    v_exp_f32 v35, v35
    v_cvt_pk_bf16_f32 v96, v32, v33
    v_cvt_pk_bf16_f32 v97, v34, v35
    v_mfma_f32_32x32x16_bf16 v[112:127], v[172:175], v[100:103], v[112:127]
    v_exp_f32 v36, v36
    v_exp_f32 v37, v37
    v_exp_f32 v38, v38
    v_exp_f32 v39, v39
    v_cvt_pk_bf16_f32 v98, v36, v37
    v_cvt_pk_bf16_f32 v99, v38, v39
    v_mfma_f32_32x32x16_bf16 v[48:63], v[156:159], v[208:211], v[48:63]
    s_barrier
    ds_read_b128 v[144:147], v198 offset:32768
    ds_read_b128 v[148:151], v198 offset:33792
    ds_read_b128 v[164:167], v198 offset:14336
    ds_read_b128 v[168:171], v198 offset:11264
    v_exp_f32 v40, v40
    v_exp_f32 v41, v41
    v_exp_f32 v42, v42
    v_exp_f32 v43, v43
    v_cvt_pk_bf16_f32 v100, v40, v41
    v_cvt_pk_bf16_f32 v101, v42, v43
    v_mfma_f32_32x32x16_bf16 v[112:127], v[160:163], v[96:99], v[112:127]
    v_exp_f32 v44, v44
    v_exp_f32 v45, v45
    v_exp_f32 v46, v46
    v_exp_f32 v47, v47
    v_cvt_pk_bf16_f32 v110, v92, v93
    v_cvt_pk_bf16_f32 v111, v94, v95
    v_mfma_f32_32x32x16_bf16 v[80:95], v[152:155], v[212:215], 0
    v_exp_f32 v64, v64
    v_exp_f32 v65, v65
    v_exp_f32 v66, v66
    v_exp_f32 v67, v67
    v_cvt_pk_bf16_f32 v104, v64, v65
    v_cvt_pk_bf16_f32 v105, v66, v67
    v_mfma_f32_32x32x16_bf16 v[128:143], v[172:175], v[108:111], v[128:143]
    v_exp_f32 v68, v68
    v_exp_f32 v69, v69
    v_exp_f32 v70, v70
    v_exp_f32 v71, v71
    v_cvt_pk_bf16_f32 v106, v68, v69
    v_cvt_pk_bf16_f32 v107, v70, v71
    v_mfma_f32_32x32x16_bf16 v[80:95], v[156:159], v[216:219], v[80:95]
    v_exp_f32 v72, v72
    v_exp_f32 v73, v73
    v_exp_f32 v74, v74
    v_exp_f32 v75, v75
    v_cvt_pk_bf16_f32 v108, v72, v73
    v_cvt_pk_bf16_f32 v109, v74, v75
    v_mfma_f32_32x32x16_bf16 v[128:143], v[160:163], v[104:107], v[128:143]
    v_exp_f32 v76, v76
    v_exp_f32 v77, v77
    v_exp_f32 v78, v78
    v_exp_f32 v79, v79
    v_cvt_pk_bf16_f32 v102, v44, v45
    v_cvt_pk_bf16_f32 v103, v46, v47
    s_waitcnt lgkmcnt(0)
    v_mfma_f32_32x32x16_bf16 v[32:47], v[144:147], v[204:207], 0
    v_exp_f32 v48, v48
    v_exp_f32 v49, v49
    v_exp_f32 v50, v50
    v_exp_f32 v51, v51
    v_cvt_pk_bf16_f32 v96, v48, v49
    v_cvt_pk_bf16_f32 v97, v50, v51
    v_mfma_f32_32x32x16_bf16 v[112:127], v[168:171], v[100:103], v[112:127]
    v_exp_f32 v52, v52
    v_exp_f32 v53, v53
    v_exp_f32 v54, v54
    v_exp_f32 v55, v55
    v_cvt_pk_bf16_f32 v98, v52, v53
    v_cvt_pk_bf16_f32 v99, v54, v55
    v_mfma_f32_32x32x16_bf16 v[32:47], v[148:151], v[208:211], v[32:47]
    ds_read_b128 v[152:155], v198 offset:36864
    ds_read_b128 v[156:159], v198 offset:37888
    ds_read_b128 v[160:163], v198 offset:34816
    ds_read_b128 v[172:175], v198 offset:15360
    v_exp_f32 v56, v56
    v_exp_f32 v57, v57
    v_exp_f32 v58, v58
    v_exp_f32 v59, v59
    v_cvt_pk_bf16_f32 v100, v56, v57
    v_cvt_pk_bf16_f32 v101, v58, v59
    v_mfma_f32_32x32x16_bf16 v[112:127], v[164:167], v[96:99], v[112:127]
    v_exp_f32 v60, v60
    v_exp_f32 v61, v61
    v_exp_f32 v62, v62
    v_exp_f32 v63, v63
    v_cvt_pk_bf16_f32 v110, v76, v77
    v_cvt_pk_bf16_f32 v111, v78, v79
    v_mfma_f32_32x32x16_bf16 v[64:79], v[144:147], v[212:215], 0
    v_exp_f32 v80, v80
    v_exp_f32 v81, v81
    v_exp_f32 v82, v82
    v_exp_f32 v83, v83
    v_cvt_pk_bf16_f32 v104, v80, v81
    v_cvt_pk_bf16_f32 v105, v82, v83
    v_mfma_f32_32x32x16_bf16 v[128:143], v[168:171], v[108:111], v[128:143]
    v_exp_f32 v84, v84
    v_exp_f32 v85, v85
    v_exp_f32 v86, v86
    v_exp_f32 v87, v87
    v_cvt_pk_bf16_f32 v106, v84, v85
    v_cvt_pk_bf16_f32 v107, v86, v87
    v_mfma_f32_32x32x16_bf16 v[64:79], v[148:151], v[216:219], v[64:79]
    v_exp_f32 v88, v88
    v_exp_f32 v89, v89
    v_exp_f32 v90, v90
    v_exp_f32 v91, v91
    v_cvt_pk_bf16_f32 v108, v88, v89
    v_cvt_pk_bf16_f32 v109, v90, v91
    v_mfma_f32_32x32x16_bf16 v[128:143], v[164:167], v[104:107], v[128:143]
    v_exp_f32 v92, v92
    v_exp_f32 v93, v93
    v_exp_f32 v94, v94
    v_exp_f32 v95, v95
    v_cvt_pk_bf16_f32 v102, v60, v61
    v_cvt_pk_bf16_f32 v103, v62, v63
    s_waitcnt lgkmcnt(0)
    v_mfma_f32_32x32x16_bf16 v[48:63], v[152:155], v[204:207], 0
    v_exp_f32 v32, v32
    v_exp_f32 v33, v33
    v_exp_f32 v34, v34
    v_exp_f32 v35, v35
    v_cvt_pk_bf16_f32 v96, v32, v33
    v_cvt_pk_bf16_f32 v97, v34, v35
    v_mfma_f32_32x32x16_bf16 v[112:127], v[172:175], v[100:103], v[112:127]
    v_exp_f32 v36, v36
    v_exp_f32 v37, v37
    v_exp_f32 v38, v38
    v_exp_f32 v39, v39
    v_cvt_pk_bf16_f32 v98, v36, v37
    v_cvt_pk_bf16_f32 v99, v38, v39
    v_mfma_f32_32x32x16_bf16 v[48:63], v[156:159], v[208:211], v[48:63]
    ds_read_b128 v[144:147], v198 offset:40960
    ds_read_b128 v[148:151], v198 offset:41984
    ds_read_b128 v[164:167], v198 offset:38912
    ds_read_b128 v[168:171], v198 offset:35840
    v_exp_f32 v40, v40
    v_exp_f32 v41, v41
    v_exp_f32 v42, v42
    v_exp_f32 v43, v43
    v_cvt_pk_bf16_f32 v100, v40, v41
    v_cvt_pk_bf16_f32 v101, v42, v43
    v_mfma_f32_32x32x16_bf16 v[112:127], v[160:163], v[96:99], v[112:127]
    v_exp_f32 v44, v44
    v_exp_f32 v45, v45
    v_exp_f32 v46, v46
    v_exp_f32 v47, v47
    v_cvt_pk_bf16_f32 v110, v92, v93
    v_cvt_pk_bf16_f32 v111, v94, v95
    v_mfma_f32_32x32x16_bf16 v[80:95], v[152:155], v[212:215], 0
    v_exp_f32 v64, v64
    v_exp_f32 v65, v65
    v_exp_f32 v66, v66
    v_exp_f32 v67, v67
    v_cvt_pk_bf16_f32 v104, v64, v65
    v_cvt_pk_bf16_f32 v105, v66, v67
    v_mfma_f32_32x32x16_bf16 v[128:143], v[172:175], v[108:111], v[128:143]
    v_exp_f32 v68, v68
    v_exp_f32 v69, v69
    v_exp_f32 v70, v70
    v_exp_f32 v71, v71
    v_cvt_pk_bf16_f32 v106, v68, v69
    v_cvt_pk_bf16_f32 v107, v70, v71
    v_mfma_f32_32x32x16_bf16 v[80:95], v[156:159], v[216:219], v[80:95]
    v_exp_f32 v72, v72
    v_exp_f32 v73, v73
    v_exp_f32 v74, v74
    v_exp_f32 v75, v75
    v_cvt_pk_bf16_f32 v108, v72, v73
    v_cvt_pk_bf16_f32 v109, v74, v75
    v_mfma_f32_32x32x16_bf16 v[128:143], v[160:163], v[104:107], v[128:143]
    v_exp_f32 v76, v76
    v_exp_f32 v77, v77
    v_exp_f32 v78, v78
    v_exp_f32 v79, v79
    v_cvt_pk_bf16_f32 v102, v44, v45
    v_cvt_pk_bf16_f32 v103, v46, v47
    s_waitcnt lgkmcnt(0)
    v_mfma_f32_32x32x16_bf16 v[32:47], v[144:147], v[204:207], 0
    v_exp_f32 v48, v48
    v_exp_f32 v49, v49
    v_exp_f32 v50, v50
    v_exp_f32 v51, v51
    v_cvt_pk_bf16_f32 v96, v48, v49
    v_cvt_pk_bf16_f32 v97, v50, v51
    v_mfma_f32_32x32x16_bf16 v[112:127], v[168:171], v[100:103], v[112:127]
    v_exp_f32 v52, v52
    v_exp_f32 v53, v53
    v_exp_f32 v54, v54
    v_exp_f32 v55, v55
    v_cvt_pk_bf16_f32 v98, v52, v53
    v_cvt_pk_bf16_f32 v99, v54, v55
    v_mfma_f32_32x32x16_bf16 v[32:47], v[148:151], v[208:211], v[32:47]
    ds_read_b128 v[152:155], v198 offset:45056
    ds_read_b128 v[156:159], v198 offset:46080
    ds_read_b128 v[160:163], v198 offset:43008
    ds_read_b128 v[172:175], v198 offset:39936
    v_exp_f32 v56, v56
    v_exp_f32 v57, v57
    v_exp_f32 v58, v58
    v_exp_f32 v59, v59
    v_cvt_pk_bf16_f32 v100, v56, v57
    v_cvt_pk_bf16_f32 v101, v58, v59
    v_mfma_f32_32x32x16_bf16 v[112:127], v[164:167], v[96:99], v[112:127]
    v_exp_f32 v60, v60
    v_exp_f32 v61, v61
    v_exp_f32 v62, v62
    v_exp_f32 v63, v63
    v_cvt_pk_bf16_f32 v110, v76, v77
    v_cvt_pk_bf16_f32 v111, v78, v79
    v_mfma_f32_32x32x16_bf16 v[64:79], v[144:147], v[212:215], 0
    v_exp_f32 v80, v80
    v_exp_f32 v81, v81
    v_exp_f32 v82, v82
    v_exp_f32 v83, v83
    v_cvt_pk_bf16_f32 v104, v80, v81
    v_cvt_pk_bf16_f32 v105, v82, v83
    v_mfma_f32_32x32x16_bf16 v[128:143], v[168:171], v[108:111], v[128:143]
    v_exp_f32 v84, v84
    v_exp_f32 v85, v85
    v_exp_f32 v86, v86
    v_exp_f32 v87, v87
    v_cvt_pk_bf16_f32 v106, v84, v85
    v_cvt_pk_bf16_f32 v107, v86, v87
    v_mfma_f32_32x32x16_bf16 v[64:79], v[148:151], v[216:219], v[64:79]
    v_exp_f32 v88, v88
    v_exp_f32 v89, v89
    v_exp_f32 v90, v90
    v_exp_f32 v91, v91
    v_cvt_pk_bf16_f32 v108, v88, v89
    v_cvt_pk_bf16_f32 v109, v90, v91
    v_mfma_f32_32x32x16_bf16 v[128:143], v[164:167], v[104:107], v[128:143]
    v_exp_f32 v92, v92
    v_exp_f32 v93, v93
    v_exp_f32 v94, v94
    v_exp_f32 v95, v95
    v_cvt_pk_bf16_f32 v102, v60, v61
    v_cvt_pk_bf16_f32 v103, v62, v63
    s_waitcnt lgkmcnt(0)
    v_mfma_f32_32x32x16_bf16 v[48:63], v[152:155], v[204:207], 0
    v_exp_f32 v32, v32
    v_exp_f32 v33, v33
    v_exp_f32 v34, v34
    v_exp_f32 v35, v35
    v_cvt_pk_bf16_f32 v96, v32, v33
    v_cvt_pk_bf16_f32 v97, v34, v35
    v_mfma_f32_32x32x16_bf16 v[112:127], v[172:175], v[100:103], v[112:127]
    v_exp_f32 v36, v36
    v_exp_f32 v37, v37
    v_exp_f32 v38, v38
    v_exp_f32 v39, v39
    v_cvt_pk_bf16_f32 v98, v36, v37
    v_cvt_pk_bf16_f32 v99, v38, v39
    v_mfma_f32_32x32x16_bf16 v[48:63], v[156:159], v[208:211], v[48:63]
    s_barrier
    s_cmp_eq_u32 s59, 0
    s_cbranch_scc1 L_nz_68
    s_waitcnt vmcnt(0)
    s_lshr_b32 s70, s54, 6
    s_lshl_b32 s70, s70, 7
    s_add_u32 s70, s70, 6619136
    v_mov_b32 v250, s70
    v_mov_b32 v251, 1
    s_mov_b64 exec, 1
    buffer_atomic_add v251, v250, s[4:7], 0 offen sc1
    s_mov_b64 exec, -1
L_nz_68:
    ds_read_b128 v[144:147], v199 offset:0
    ds_read_b128 v[148:151], v199 offset:1024
    ds_read_b128 v[164:167], v198 offset:47104
    ds_read_b128 v[168:171], v198 offset:44032
    v_exp_f32 v40, v40
    v_exp_f32 v41, v41
    v_exp_f32 v42, v42
    v_exp_f32 v43, v43
    v_cvt_pk_bf16_f32 v100, v40, v41
    v_cvt_pk_bf16_f32 v101, v42, v43
    v_mfma_f32_32x32x16_bf16 v[112:127], v[160:163], v[96:99], v[112:127]
    v_exp_f32 v44, v44
    v_exp_f32 v45, v45
    v_exp_f32 v46, v46
    v_exp_f32 v47, v47
    v_cvt_pk_bf16_f32 v110, v92, v93
    v_cvt_pk_bf16_f32 v111, v94, v95
    v_mfma_f32_32x32x16_bf16 v[80:95], v[152:155], v[212:215], 0
    v_exp_f32 v64, v64
    v_exp_f32 v65, v65
    v_exp_f32 v66, v66
    v_exp_f32 v67, v67
    v_cvt_pk_bf16_f32 v104, v64, v65
    v_cvt_pk_bf16_f32 v105, v66, v67
    v_mfma_f32_32x32x16_bf16 v[128:143], v[172:175], v[108:111], v[128:143]
    v_exp_f32 v68, v68
    v_exp_f32 v69, v69
    v_exp_f32 v70, v70
    v_exp_f32 v71, v71
    v_cvt_pk_bf16_f32 v106, v68, v69
    v_cvt_pk_bf16_f32 v107, v70, v71
    v_mfma_f32_32x32x16_bf16 v[80:95], v[156:159], v[216:219], v[80:95]
    v_exp_f32 v72, v72
    v_exp_f32 v73, v73
    v_exp_f32 v74, v74
    v_exp_f32 v75, v75
    v_cvt_pk_bf16_f32 v108, v72, v73
    v_cvt_pk_bf16_f32 v109, v74, v75
    v_mfma_f32_32x32x16_bf16 v[128:143], v[160:163], v[104:107], v[128:143]
    v_exp_f32 v76, v76
    v_exp_f32 v77, v77
    v_exp_f32 v78, v78
    v_exp_f32 v79, v79
    v_cvt_pk_bf16_f32 v102, v44, v45
    v_cvt_pk_bf16_f32 v103, v46, v47
    s_waitcnt lgkmcnt(0)
    v_mfma_f32_32x32x16_bf16 v[32:47], v[144:147], v[204:207], 0
    v_exp_f32 v48, v48
    v_exp_f32 v49, v49
    v_exp_f32 v50, v50
    v_exp_f32 v51, v51
    v_cvt_pk_bf16_f32 v96, v48, v49
    v_cvt_pk_bf16_f32 v97, v50, v51
    v_mfma_f32_32x32x16_bf16 v[112:127], v[168:171], v[100:103], v[112:127]
    v_exp_f32 v52, v52
    v_exp_f32 v53, v53
    v_exp_f32 v54, v54
    v_exp_f32 v55, v55
    v_cvt_pk_bf16_f32 v98, v52, v53
    v_cvt_pk_bf16_f32 v99, v54, v55
    v_mfma_f32_32x32x16_bf16 v[32:47], v[148:151], v[208:211], v[32:47]
    ds_read_b128 v[152:155], v199 offset:4096
    ds_read_b128 v[156:159], v199 offset:5120
    ds_read_b128 v[160:163], v199 offset:2048
    ds_read_b128 v[172:175], v198 offset:48128
    v_exp_f32 v56, v56
    v_exp_f32 v57, v57
    v_exp_f32 v58, v58
    v_exp_f32 v59, v59
    v_cvt_pk_bf16_f32 v100, v56, v57
    v_cvt_pk_bf16_f32 v101, v58, v59
    v_mfma_f32_32x32x16_bf16 v[112:127], v[164:167], v[96:99], v[112:127]
    v_exp_f32 v60, v60
    v_exp_f32 v61, v61
    v_exp_f32 v62, v62
    v_exp_f32 v63, v63
    v_cvt_pk_bf16_f32 v110, v76, v77
    v_cvt_pk_bf16_f32 v111, v78, v79
    v_mfma_f32_32x32x16_bf16 v[64:79], v[144:147], v[212:215], 0
    v_exp_f32 v80, v80
    v_exp_f32 v81, v81
    v_exp_f32 v82, v82
    v_exp_f32 v83, v83
    v_cvt_pk_bf16_f32 v104, v80, v81
    v_cvt_pk_bf16_f32 v105, v82, v83
    v_mfma_f32_32x32x16_bf16 v[128:143], v[168:171], v[108:111], v[128:143]
    v_exp_f32 v84, v84
    v_exp_f32 v85, v85
    v_exp_f32 v86, v86
    v_exp_f32 v87, v87
    v_cvt_pk_bf16_f32 v106, v84, v85
    v_cvt_pk_bf16_f32 v107, v86, v87
    v_mfma_f32_32x32x16_bf16 v[64:79], v[148:151], v[216:219], v[64:79]
    v_exp_f32 v88, v88
    v_exp_f32 v89, v89
    v_exp_f32 v90, v90
    v_exp_f32 v91, v91
    v_cvt_pk_bf16_f32 v108, v88, v89
    v_cvt_pk_bf16_f32 v109, v90, v91
    v_mfma_f32_32x32x16_bf16 v[128:143], v[164:167], v[104:107], v[128:143]
    v_exp_f32 v92, v92
    v_exp_f32 v93, v93
    v_exp_f32 v94, v94
    v_exp_f32 v95, v95
    v_cvt_pk_bf16_f32 v102, v60, v61
    v_cvt_pk_bf16_f32 v103, v62, v63
    s_waitcnt lgkmcnt(0)
    v_mfma_f32_32x32x16_bf16 v[48:63], v[152:155], v[204:207], 0
    v_exp_f32 v32, v32
    v_exp_f32 v33, v33
    v_exp_f32 v34, v34
    v_exp_f32 v35, v35
    v_cvt_pk_bf16_f32 v96, v32, v33
    v_cvt_pk_bf16_f32 v97, v34, v35
    v_mfma_f32_32x32x16_bf16 v[112:127], v[172:175], v[100:103], v[112:127]
    v_exp_f32 v36, v36
    v_exp_f32 v37, v37
    v_exp_f32 v38, v38
    v_exp_f32 v39, v39
    v_cvt_pk_bf16_f32 v98, v36, v37
    v_cvt_pk_bf16_f32 v99, v38, v39
    v_mfma_f32_32x32x16_bf16 v[48:63], v[156:159], v[208:211], v[48:63]
    ds_read_b128 v[144:147], v199 offset:8192
    ds_read_b128 v[148:151], v199 offset:9216
    ds_read_b128 v[164:167], v199 offset:6144
    ds_read_b128 v[168:171], v199 offset:3072
    v_exp_f32 v40, v40
    v_exp_f32 v41, v41
    v_exp_f32 v42, v42
    v_exp_f32 v43, v43
    v_cvt_pk_bf16_f32 v100, v40, v41
    v_cvt_pk_bf16_f32 v101, v42, v43
    v_mfma_f32_32x32x16_bf16 v[112:127], v[160:163], v[96:99], v[112:127]
    v_exp_f32 v44, v44
    v_exp_f32 v45, v45
    v_exp_f32 v46, v46
    v_exp_f32 v47, v47
    v_cvt_pk_bf16_f32 v110, v92, v93
    v_cvt_pk_bf16_f32 v111, v94, v95
    v_mfma_f32_32x32x16_bf16 v[80:95], v[152:155], v[212:215], 0
    v_exp_f32 v64, v64
    v_exp_f32 v65, v65
    v_exp_f32 v66, v66
    v_exp_f32 v67, v67
    v_cvt_pk_bf16_f32 v104, v64, v65
    v_cvt_pk_bf16_f32 v105, v66, v67
    v_mfma_f32_32x32x16_bf16 v[128:143], v[172:175], v[108:111], v[128:143]
    v_exp_f32 v68, v68
    v_exp_f32 v69, v69
    v_exp_f32 v70, v70
    v_exp_f32 v71, v71
    v_cvt_pk_bf16_f32 v106, v68, v69
    v_cvt_pk_bf16_f32 v107, v70, v71
    v_mfma_f32_32x32x16_bf16 v[80:95], v[156:159], v[216:219], v[80:95]
    v_exp_f32 v72, v72
    v_exp_f32 v73, v73
    v_exp_f32 v74, v74
    v_exp_f32 v75, v75
    v_cvt_pk_bf16_f32 v108, v72, v73
    v_cvt_pk_bf16_f32 v109, v74, v75
    v_mfma_f32_32x32x16_bf16 v[128:143], v[160:163], v[104:107], v[128:143]
    v_exp_f32 v76, v76
    v_exp_f32 v77, v77
    v_exp_f32 v78, v78
    v_exp_f32 v79, v79
    v_cvt_pk_bf16_f32 v102, v44, v45
    v_cvt_pk_bf16_f32 v103, v46, v47
    s_waitcnt lgkmcnt(0)
    v_mfma_f32_32x32x16_bf16 v[32:47], v[144:147], v[204:207], 0
    v_exp_f32 v48, v48
    v_exp_f32 v49, v49
    v_exp_f32 v50, v50
    v_exp_f32 v51, v51
    v_cvt_pk_bf16_f32 v96, v48, v49
    v_cvt_pk_bf16_f32 v97, v50, v51
    v_mfma_f32_32x32x16_bf16 v[112:127], v[168:171], v[100:103], v[112:127]
    v_exp_f32 v52, v52
    v_exp_f32 v53, v53
    v_exp_f32 v54, v54
    v_exp_f32 v55, v55
    v_cvt_pk_bf16_f32 v98, v52, v53
    v_cvt_pk_bf16_f32 v99, v54, v55
    v_mfma_f32_32x32x16_bf16 v[32:47], v[148:151], v[208:211], v[32:47]
    ds_read_b128 v[152:155], v199 offset:12288
    ds_read_b128 v[156:159], v199 offset:13312
    ds_read_b128 v[160:163], v199 offset:10240
    ds_read_b128 v[172:175], v199 offset:7168
    v_exp_f32 v56, v56
    v_exp_f32 v57, v57
    v_exp_f32 v58, v58
    v_exp_f32 v59, v59
    v_cvt_pk_bf16_f32 v100, v56, v57
    v_cvt_pk_bf16_f32 v101, v58, v59
    v_mfma_f32_32x32x16_bf16 v[112:127], v[164:167], v[96:99], v[112:127]
    v_exp_f32 v60, v60
    v_exp_f32 v61, v61
    v_exp_f32 v62, v62
    v_exp_f32 v63, v63
    v_cvt_pk_bf16_f32 v110, v76, v77
    v_cvt_pk_bf16_f32 v111, v78, v79
    v_mfma_f32_32x32x16_bf16 v[64:79], v[144:147], v[212:215], 0
    v_exp_f32 v80, v80
    v_exp_f32 v81, v81
    v_exp_f32 v82, v82
    v_exp_f32 v83, v83
    v_cvt_pk_bf16_f32 v104, v80, v81
    v_cvt_pk_bf16_f32 v105, v82, v83
    v_mfma_f32_32x32x16_bf16 v[128:143], v[168:171], v[108:111], v[128:143]
    v_exp_f32 v84, v84
    v_exp_f32 v85, v85
    v_exp_f32 v86, v86
    v_exp_f32 v87, v87
    v_cvt_pk_bf16_f32 v106, v84, v85
    v_cvt_pk_bf16_f32 v107, v86, v87
    v_mfma_f32_32x32x16_bf16 v[64:79], v[148:151], v[216:219], v[64:79]
    v_exp_f32 v88, v88
    v_exp_f32 v89, v89
    v_exp_f32 v90, v90
    v_exp_f32 v91, v91
    v_cvt_pk_bf16_f32 v108, v88, v89
    v_cvt_pk_bf16_f32 v109, v90, v91
    v_mfma_f32_32x32x16_bf16 v[128:143], v[164:167], v[104:107], v[128:143]
    v_exp_f32 v92, v92
    v_exp_f32 v93, v93
    v_exp_f32 v94, v94
    v_exp_f32 v95, v95
    v_cvt_pk_bf16_f32 v102, v60, v61
    v_cvt_pk_bf16_f32 v103, v62, v63
    s_waitcnt lgkmcnt(0)
    v_mfma_f32_32x32x16_bf16 v[48:63], v[152:155], v[204:207], 0
    v_exp_f32 v32, v32
    v_exp_f32 v33, v33
    v_exp_f32 v34, v34
    v_exp_f32 v35, v35
    v_cvt_pk_bf16_f32 v96, v32, v33
    v_cvt_pk_bf16_f32 v97, v34, v35
    v_mfma_f32_32x32x16_bf16 v[112:127], v[172:175], v[100:103], v[112:127]
    v_exp_f32 v36, v36
    v_exp_f32 v37, v37
    v_exp_f32 v38, v38
    v_exp_f32 v39, v39
    v_cvt_pk_bf16_f32 v98, v36, v37
    v_cvt_pk_bf16_f32 v99, v38, v39
    v_mfma_f32_32x32x16_bf16 v[48:63], v[156:159], v[208:211], v[48:63]
    s_barrier
    ds_read_b128 v[144:147], v199 offset:32768
    ds_read_b128 v[148:151], v199 offset:33792
    ds_read_b128 v[164:167], v199 offset:14336
    ds_read_b128 v[168:171], v199 offset:11264
    v_exp_f32 v40, v40
    v_exp_f32 v41, v41
    v_exp_f32 v42, v42
    v_exp_f32 v43, v43
    v_cvt_pk_bf16_f32 v100, v40, v41
    v_cvt_pk_bf16_f32 v101, v42, v43
    v_mfma_f32_32x32x16_bf16 v[112:127], v[160:163], v[96:99], v[112:127]
    v_exp_f32 v44, v44
    v_exp_f32 v45, v45
    v_exp_f32 v46, v46
    v_exp_f32 v47, v47
    v_cvt_pk_bf16_f32 v110, v92, v93
    v_cvt_pk_bf16_f32 v111, v94, v95
    v_mfma_f32_32x32x16_bf16 v[80:95], v[152:155], v[212:215], 0
    v_exp_f32 v64, v64
    v_exp_f32 v65, v65
    v_exp_f32 v66, v66
    v_exp_f32 v67, v67
    v_cvt_pk_bf16_f32 v104, v64, v65
    v_cvt_pk_bf16_f32 v105, v66, v67
    v_mfma_f32_32x32x16_bf16 v[128:143], v[172:175], v[108:111], v[128:143]
    v_exp_f32 v68, v68
    v_exp_f32 v69, v69
    v_exp_f32 v70, v70
    v_exp_f32 v71, v71
    v_cvt_pk_bf16_f32 v106, v68, v69
    v_cvt_pk_bf16_f32 v107, v70, v71
    v_mfma_f32_32x32x16_bf16 v[80:95], v[156:159], v[216:219], v[80:95]
    v_exp_f32 v72, v72
    v_exp_f32 v73, v73
    v_exp_f32 v74, v74
    v_exp_f32 v75, v75
    v_cvt_pk_bf16_f32 v108, v72, v73
    v_cvt_pk_bf16_f32 v109, v74, v75
    v_mfma_f32_32x32x16_bf16 v[128:143], v[160:163], v[104:107], v[128:143]
    v_exp_f32 v76, v76
    v_exp_f32 v77, v77
    v_exp_f32 v78, v78
    v_exp_f32 v79, v79
    v_cvt_pk_bf16_f32 v102, v44, v45
    v_cvt_pk_bf16_f32 v103, v46, v47
    s_waitcnt lgkmcnt(0)
    v_mfma_f32_32x32x16_bf16 v[32:47], v[144:147], v[204:207], 0
    v_exp_f32 v48, v48
    v_exp_f32 v49, v49
    v_exp_f32 v50, v50
    v_exp_f32 v51, v51
    v_cvt_pk_bf16_f32 v96, v48, v49
    v_cvt_pk_bf16_f32 v97, v50, v51
    v_mfma_f32_32x32x16_bf16 v[112:127], v[168:171], v[100:103], v[112:127]
    v_exp_f32 v52, v52
    v_exp_f32 v53, v53
    v_exp_f32 v54, v54
    v_exp_f32 v55, v55
    v_cvt_pk_bf16_f32 v98, v52, v53
    v_cvt_pk_bf16_f32 v99, v54, v55
    v_mfma_f32_32x32x16_bf16 v[32:47], v[148:151], v[208:211], v[32:47]
    ds_read_b128 v[152:155], v199 offset:36864
    ds_read_b128 v[156:159], v199 offset:37888
    ds_read_b128 v[160:163], v199 offset:34816
    ds_read_b128 v[172:175], v199 offset:15360
    v_exp_f32 v56, v56
    v_exp_f32 v57, v57
    v_exp_f32 v58, v58
    v_exp_f32 v59, v59
    v_cvt_pk_bf16_f32 v100, v56, v57
    v_cvt_pk_bf16_f32 v101, v58, v59
    v_mfma_f32_32x32x16_bf16 v[112:127], v[164:167], v[96:99], v[112:127]
    v_exp_f32 v60, v60
    v_exp_f32 v61, v61
    v_exp_f32 v62, v62
    v_exp_f32 v63, v63
    v_cvt_pk_bf16_f32 v110, v76, v77
    v_cvt_pk_bf16_f32 v111, v78, v79
    v_mfma_f32_32x32x16_bf16 v[64:79], v[144:147], v[212:215], 0
    v_exp_f32 v80, v80
    v_exp_f32 v81, v81
    v_exp_f32 v82, v82
    v_exp_f32 v83, v83
    v_cvt_pk_bf16_f32 v104, v80, v81
    v_cvt_pk_bf16_f32 v105, v82, v83
    v_mfma_f32_32x32x16_bf16 v[128:143], v[168:171], v[108:111], v[128:143]
    v_exp_f32 v84, v84
    v_exp_f32 v85, v85
    v_exp_f32 v86, v86
    v_exp_f32 v87, v87
    v_cvt_pk_bf16_f32 v106, v84, v85
    v_cvt_pk_bf16_f32 v107, v86, v87
    v_mfma_f32_32x32x16_bf16 v[64:79], v[148:151], v[216:219], v[64:79]
    v_exp_f32 v88, v88
    v_exp_f32 v89, v89
    v_exp_f32 v90, v90
    v_exp_f32 v91, v91
    v_cvt_pk_bf16_f32 v108, v88, v89
    v_cvt_pk_bf16_f32 v109, v90, v91
    v_mfma_f32_32x32x16_bf16 v[128:143], v[164:167], v[104:107], v[128:143]
    v_exp_f32 v92, v92
    v_exp_f32 v93, v93
    v_exp_f32 v94, v94
    v_exp_f32 v95, v95
    v_cvt_pk_bf16_f32 v102, v60, v61
    v_cvt_pk_bf16_f32 v103, v62, v63
    s_waitcnt lgkmcnt(0)
    v_mfma_f32_32x32x16_bf16 v[48:63], v[152:155], v[204:207], 0
    v_exp_f32 v32, v32
    v_exp_f32 v33, v33
    v_exp_f32 v34, v34
    v_exp_f32 v35, v35
    v_cvt_pk_bf16_f32 v96, v32, v33
    v_cvt_pk_bf16_f32 v97, v34, v35
    v_mfma_f32_32x32x16_bf16 v[112:127], v[172:175], v[100:103], v[112:127]
    v_exp_f32 v36, v36
    v_exp_f32 v37, v37
    v_exp_f32 v38, v38
    v_exp_f32 v39, v39
    v_cvt_pk_bf16_f32 v98, v36, v37
    v_cvt_pk_bf16_f32 v99, v38, v39
    v_mfma_f32_32x32x16_bf16 v[48:63], v[156:159], v[208:211], v[48:63]
    ds_read_b128 v[144:147], v199 offset:40960
    ds_read_b128 v[148:151], v199 offset:41984
    ds_read_b128 v[164:167], v199 offset:38912
    ds_read_b128 v[168:171], v199 offset:35840
    v_exp_f32 v40, v40
    v_exp_f32 v41, v41
    v_exp_f32 v42, v42
    v_exp_f32 v43, v43
    v_cvt_pk_bf16_f32 v100, v40, v41
    v_cvt_pk_bf16_f32 v101, v42, v43
    v_mfma_f32_32x32x16_bf16 v[112:127], v[160:163], v[96:99], v[112:127]
    v_exp_f32 v44, v44
    v_exp_f32 v45, v45
    v_exp_f32 v46, v46
    v_exp_f32 v47, v47
    v_cvt_pk_bf16_f32 v110, v92, v93
    v_cvt_pk_bf16_f32 v111, v94, v95
    v_mfma_f32_32x32x16_bf16 v[80:95], v[152:155], v[212:215], 0
    v_exp_f32 v64, v64
    v_exp_f32 v65, v65
    v_exp_f32 v66, v66
    v_exp_f32 v67, v67
    v_cvt_pk_bf16_f32 v104, v64, v65
    v_cvt_pk_bf16_f32 v105, v66, v67
    v_mfma_f32_32x32x16_bf16 v[128:143], v[172:175], v[108:111], v[128:143]
    v_exp_f32 v68, v68
    v_exp_f32 v69, v69
    v_exp_f32 v70, v70
    v_exp_f32 v71, v71
    v_cvt_pk_bf16_f32 v106, v68, v69
    v_cvt_pk_bf16_f32 v107, v70, v71
    v_mfma_f32_32x32x16_bf16 v[80:95], v[156:159], v[216:219], v[80:95]
    v_exp_f32 v72, v72
    v_exp_f32 v73, v73
    v_exp_f32 v74, v74
    v_exp_f32 v75, v75
    v_cvt_pk_bf16_f32 v108, v72, v73
    v_cvt_pk_bf16_f32 v109, v74, v75
    v_mfma_f32_32x32x16_bf16 v[128:143], v[160:163], v[104:107], v[128:143]
    v_exp_f32 v76, v76
    v_exp_f32 v77, v77
    v_exp_f32 v78, v78
    v_exp_f32 v79, v79
    v_cvt_pk_bf16_f32 v102, v44, v45
    v_cvt_pk_bf16_f32 v103, v46, v47
    s_waitcnt lgkmcnt(0)
    v_mfma_f32_32x32x16_bf16 v[32:47], v[144:147], v[204:207], 0
    v_exp_f32 v48, v48
    v_exp_f32 v49, v49
    v_exp_f32 v50, v50
    v_exp_f32 v51, v51
    v_cvt_pk_bf16_f32 v96, v48, v49
    v_cvt_pk_bf16_f32 v97, v50, v51
    v_mfma_f32_32x32x16_bf16 v[112:127], v[168:171], v[100:103], v[112:127]
    v_exp_f32 v52, v52
    v_exp_f32 v53, v53
    v_exp_f32 v54, v54
    v_exp_f32 v55, v55
    v_cvt_pk_bf16_f32 v98, v52, v53
    v_cvt_pk_bf16_f32 v99, v54, v55
    v_mfma_f32_32x32x16_bf16 v[32:47], v[148:151], v[208:211], v[32:47]
    ds_read_b128 v[152:155], v199 offset:45056
    ds_read_b128 v[156:159], v199 offset:46080
    ds_read_b128 v[160:163], v199 offset:43008
    ds_read_b128 v[172:175], v199 offset:39936
    v_exp_f32 v56, v56
    v_exp_f32 v57, v57
    v_exp_f32 v58, v58
    v_exp_f32 v59, v59
    v_cvt_pk_bf16_f32 v100, v56, v57
    v_cvt_pk_bf16_f32 v101, v58, v59
    v_mfma_f32_32x32x16_bf16 v[112:127], v[164:167], v[96:99], v[112:127]
    v_exp_f32 v60, v60
    v_exp_f32 v61, v61
    v_exp_f32 v62, v62
    v_exp_f32 v63, v63
    v_cvt_pk_bf16_f32 v110, v76, v77
    v_cvt_pk_bf16_f32 v111, v78, v79
    v_mfma_f32_32x32x16_bf16 v[64:79], v[144:147], v[212:215], 0
    v_exp_f32 v80, v80
    v_exp_f32 v81, v81
    v_exp_f32 v82, v82
    v_exp_f32 v83, v83
    v_cvt_pk_bf16_f32 v104, v80, v81
    v_cvt_pk_bf16_f32 v105, v82, v83
    v_mfma_f32_32x32x16_bf16 v[128:143], v[168:171], v[108:111], v[128:143]
    v_exp_f32 v84, v84
    v_exp_f32 v85, v85
    v_exp_f32 v86, v86
    v_exp_f32 v87, v87
    v_cvt_pk_bf16_f32 v106, v84, v85
    v_cvt_pk_bf16_f32 v107, v86, v87
    v_mfma_f32_32x32x16_bf16 v[64:79], v[148:151], v[216:219], v[64:79]
    v_exp_f32 v88, v88
    v_exp_f32 v89, v89
    v_exp_f32 v90, v90
    v_exp_f32 v91, v91
    v_cvt_pk_bf16_f32 v108, v88, v89
    v_cvt_pk_bf16_f32 v109, v90, v91
    v_mfma_f32_32x32x16_bf16 v[128:143], v[164:167], v[104:107], v[128:143]
    v_exp_f32 v92, v92
    v_exp_f32 v93, v93
    v_exp_f32 v94, v94
    v_exp_f32 v95, v95
    v_cvt_pk_bf16_f32 v102, v60, v61
    v_cvt_pk_bf16_f32 v103, v62, v63
    s_waitcnt lgkmcnt(0)
    v_mfma_f32_32x32x16_bf16 v[48:63], v[152:155], v[204:207], 0
    v_exp_f32 v32, v32
    v_exp_f32 v33, v33
    v_exp_f32 v34, v34
    v_exp_f32 v35, v35
    v_cvt_pk_bf16_f32 v96, v32, v33
    v_cvt_pk_bf16_f32 v97, v34, v35
    v_mfma_f32_32x32x16_bf16 v[112:127], v[172:175], v[100:103], v[112:127]
    v_exp_f32 v36, v36
    v_exp_f32 v37, v37
    v_exp_f32 v38, v38
    v_exp_f32 v39, v39
    v_cvt_pk_bf16_f32 v98, v36, v37
    v_cvt_pk_bf16_f32 v99, v38, v39
    v_mfma_f32_32x32x16_bf16 v[48:63], v[156:159], v[208:211], v[48:63]
    s_barrier
    ds_read_b128 v[144:147], v198 offset:0
    ds_read_b128 v[148:151], v198 offset:1024
    ds_read_b128 v[164:167], v199 offset:47104
    ds_read_b128 v[168:171], v199 offset:44032
    v_exp_f32 v40, v40
    v_exp_f32 v41, v41
    v_exp_f32 v42, v42
    v_exp_f32 v43, v43
    v_cvt_pk_bf16_f32 v100, v40, v41
    v_cvt_pk_bf16_f32 v101, v42, v43
    v_mfma_f32_32x32x16_bf16 v[112:127], v[160:163], v[96:99], v[112:127]
    v_exp_f32 v44, v44
    v_exp_f32 v45, v45
    v_exp_f32 v46, v46
    v_exp_f32 v47, v47
    v_cvt_pk_bf16_f32 v110, v92, v93
    v_cvt_pk_bf16_f32 v111, v94, v95
    v_mfma_f32_32x32x16_bf16 v[80:95], v[152:155], v[212:215], 0
    v_exp_f32 v64, v64
    v_exp_f32 v65, v65
    v_exp_f32 v66, v66
    v_exp_f32 v67, v67
    v_cvt_pk_bf16_f32 v104, v64, v65
    v_cvt_pk_bf16_f32 v105, v66, v67
    v_mfma_f32_32x32x16_bf16 v[128:143], v[172:175], v[108:111], v[128:143]
    v_exp_f32 v68, v68
    v_exp_f32 v69, v69
    v_exp_f32 v70, v70
    v_exp_f32 v71, v71
    v_cvt_pk_bf16_f32 v106, v68, v69
    v_cvt_pk_bf16_f32 v107, v70, v71
    v_mfma_f32_32x32x16_bf16 v[80:95], v[156:159], v[216:219], v[80:95]
    v_exp_f32 v72, v72
    v_exp_f32 v73, v73
    v_exp_f32 v74, v74
    v_exp_f32 v75, v75
    v_cvt_pk_bf16_f32 v108, v72, v73
    v_cvt_pk_bf16_f32 v109, v74, v75
    v_mfma_f32_32x32x16_bf16 v[128:143], v[160:163], v[104:107], v[128:143]
    v_exp_f32 v76, v76
    v_exp_f32 v77, v77
    v_exp_f32 v78, v78
    v_exp_f32 v79, v79
    v_cvt_pk_bf16_f32 v102, v44, v45
    v_cvt_pk_bf16_f32 v103, v46, v47
    s_waitcnt lgkmcnt(0)
    v_mfma_f32_32x32x16_bf16 v[32:47], v[144:147], v[204:207], 0
    v_exp_f32 v48, v48
    v_exp_f32 v49, v49
    v_exp_f32 v50, v50
    v_exp_f32 v51, v51
    v_cvt_pk_bf16_f32 v96, v48, v49
    v_cvt_pk_bf16_f32 v97, v50, v51
    v_mfma_f32_32x32x16_bf16 v[112:127], v[168:171], v[100:103], v[112:127]
    v_exp_f32 v52, v52
    v_exp_f32 v53, v53
    v_exp_f32 v54, v54
    v_exp_f32 v55, v55
    v_cvt_pk_bf16_f32 v98, v52, v53
    v_cvt_pk_bf16_f32 v99, v54, v55
    v_mfma_f32_32x32x16_bf16 v[32:47], v[148:151], v[208:211], v[32:47]
    ds_read_b128 v[152:155], v198 offset:4096
    ds_read_b128 v[156:159], v198 offset:5120
    ds_read_b128 v[160:163], v198 offset:2048
    ds_read_b128 v[172:175], v199 offset:48128
    v_exp_f32 v56, v56
    v_exp_f32 v57, v57
    v_exp_f32 v58, v58
    v_exp_f32 v59, v59
    v_cvt_pk_bf16_f32 v100, v56, v57
    v_cvt_pk_bf16_f32 v101, v58, v59
    v_mfma_f32_32x32x16_bf16 v[112:127], v[164:167], v[96:99], v[112:127]
    v_exp_f32 v60, v60
    v_exp_f32 v61, v61
    v_exp_f32 v62, v62
    v_exp_f32 v63, v63
    v_cvt_pk_bf16_f32 v110, v76, v77
    v_cvt_pk_bf16_f32 v111, v78, v79
    v_mfma_f32_32x32x16_bf16 v[64:79], v[144:147], v[212:215], 0
    v_exp_f32 v80, v80
    v_exp_f32 v81, v81
    v_exp_f32 v82, v82
    v_exp_f32 v83, v83
    v_cvt_pk_bf16_f32 v104, v80, v81
    v_cvt_pk_bf16_f32 v105, v82, v83
    v_mfma_f32_32x32x16_bf16 v[128:143], v[168:171], v[108:111], v[128:143]
    v_exp_f32 v84, v84
    v_exp_f32 v85, v85
    v_exp_f32 v86, v86
    v_exp_f32 v87, v87
    v_cvt_pk_bf16_f32 v106, v84, v85
    v_cvt_pk_bf16_f32 v107, v86, v87
    v_mfma_f32_32x32x16_bf16 v[64:79], v[148:151], v[216:219], v[64:79]
    v_exp_f32 v88, v88
    v_exp_f32 v89, v89
    v_exp_f32 v90, v90
    v_exp_f32 v91, v91
    v_cvt_pk_bf16_f32 v108, v88, v89
    v_cvt_pk_bf16_f32 v109, v90, v91
    v_mfma_f32_32x32x16_bf16 v[128:143], v[164:167], v[104:107], v[128:143]
    v_exp_f32 v92, v92
    v_exp_f32 v93, v93
    v_exp_f32 v94, v94
    v_exp_f32 v95, v95
    v_cvt_pk_bf16_f32 v102, v60, v61
    v_cvt_pk_bf16_f32 v103, v62, v63
    s_waitcnt lgkmcnt(0)
    v_mfma_f32_32x32x16_bf16 v[48:63], v[152:155], v[204:207], 0
    v_exp_f32 v32, v32
    v_exp_f32 v33, v33
    v_exp_f32 v34, v34
    v_exp_f32 v35, v35
    v_cvt_pk_bf16_f32 v96, v32, v33
    v_cvt_pk_bf16_f32 v97, v34, v35
    v_mfma_f32_32x32x16_bf16 v[112:127], v[172:175], v[100:103], v[112:127]
    v_exp_f32 v36, v36
    v_exp_f32 v37, v37
    v_exp_f32 v38, v38
    v_exp_f32 v39, v39
    v_cvt_pk_bf16_f32 v98, v36, v37
    v_cvt_pk_bf16_f32 v99, v38, v39
    v_mfma_f32_32x32x16_bf16 v[48:63], v[156:159], v[208:211], v[48:63]
    ds_read_b128 v[144:147], v198 offset:8192
    ds_read_b128 v[148:151], v198 offset:9216
    ds_read_b128 v[164:167], v198 offset:6144
    ds_read_b128 v[168:171], v198 offset:3072
    v_exp_f32 v40, v40
    v_exp_f32 v41, v41
    v_exp_f32 v42, v42
    v_exp_f32 v43, v43
    v_cvt_pk_bf16_f32 v100, v40, v41
    v_cvt_pk_bf16_f32 v101, v42, v43
    v_mfma_f32_32x32x16_bf16 v[112:127], v[160:163], v[96:99], v[112:127]
    v_exp_f32 v44, v44
    v_exp_f32 v45, v45
    v_exp_f32 v46, v46
    v_exp_f32 v47, v47
    v_cvt_pk_bf16_f32 v110, v92, v93
    v_cvt_pk_bf16_f32 v111, v94, v95
    v_mfma_f32_32x32x16_bf16 v[80:95], v[152:155], v[212:215], 0
    v_exp_f32 v64, v64
    v_exp_f32 v65, v65
    v_exp_f32 v66, v66
    v_exp_f32 v67, v67
    v_cvt_pk_bf16_f32 v104, v64, v65
    v_cvt_pk_bf16_f32 v105, v66, v67
    v_mfma_f32_32x32x16_bf16 v[128:143], v[172:175], v[108:111], v[128:143]
    v_exp_f32 v68, v68
    v_exp_f32 v69, v69
    v_exp_f32 v70, v70
    v_exp_f32 v71, v71
    v_cvt_pk_bf16_f32 v106, v68, v69
    v_cvt_pk_bf16_f32 v107, v70, v71
    v_mfma_f32_32x32x16_bf16 v[80:95], v[156:159], v[216:219], v[80:95]
    v_exp_f32 v72, v72
    v_exp_f32 v73, v73
    v_exp_f32 v74, v74
    v_exp_f32 v75, v75
    v_cvt_pk_bf16_f32 v108, v72, v73
    v_cvt_pk_bf16_f32 v109, v74, v75
    v_mfma_f32_32x32x16_bf16 v[128:143], v[160:163], v[104:107], v[128:143]
    v_exp_f32 v76, v76
    v_exp_f32 v77, v77
    v_exp_f32 v78, v78
    v_exp_f32 v79, v79
    v_cvt_pk_bf16_f32 v102, v44, v45
    v_cvt_pk_bf16_f32 v103, v46, v47
    s_waitcnt lgkmcnt(0)
    v_mfma_f32_32x32x16_bf16 v[32:47], v[144:147], v[204:207], 0
    v_exp_f32 v48, v48
    v_exp_f32 v49, v49
    v_exp_f32 v50, v50
    v_exp_f32 v51, v51
    v_cvt_pk_bf16_f32 v96, v48, v49
    v_cvt_pk_bf16_f32 v97, v50, v51
    v_mfma_f32_32x32x16_bf16 v[112:127], v[168:171], v[100:103], v[112:127]
    v_exp_f32 v52, v52
    v_exp_f32 v53, v53
    v_exp_f32 v54, v54
    v_exp_f32 v55, v55
    v_cvt_pk_bf16_f32 v98, v52, v53
    v_cvt_pk_bf16_f32 v99, v54, v55
    v_mfma_f32_32x32x16_bf16 v[32:47], v[148:151], v[208:211], v[32:47]
    ds_read_b128 v[152:155], v198 offset:12288
    ds_read_b128 v[156:159], v198 offset:13312
    ds_read_b128 v[160:163], v198 offset:10240
    ds_read_b128 v[172:175], v198 offset:7168
    v_exp_f32 v56, v56
    v_exp_f32 v57, v57
    v_exp_f32 v58, v58
    v_exp_f32 v59, v59
    v_cvt_pk_bf16_f32 v100, v56, v57
    v_cvt_pk_bf16_f32 v101, v58, v59
    v_mfma_f32_32x32x16_bf16 v[112:127], v[164:167], v[96:99], v[112:127]
    v_exp_f32 v60, v60
    v_exp_f32 v61, v61
    v_exp_f32 v62, v62
    v_exp_f32 v63, v63
    v_cvt_pk_bf16_f32 v110, v76, v77
    v_cvt_pk_bf16_f32 v111, v78, v79
    v_mfma_f32_32x32x16_bf16 v[64:79], v[144:147], v[212:215], 0
    v_exp_f32 v80, v80
    v_exp_f32 v81, v81
    v_exp_f32 v82, v82
    v_exp_f32 v83, v83
    v_cvt_pk_bf16_f32 v104, v80, v81
    v_cvt_pk_bf16_f32 v105, v82, v83
    v_mfma_f32_32x32x16_bf16 v[128:143], v[168:171], v[108:111], v[128:143]
    v_exp_f32 v84, v84
    v_exp_f32 v85, v85
    v_exp_f32 v86, v86
    v_exp_f32 v87, v87
    v_cvt_pk_bf16_f32 v106, v84, v85
    v_cvt_pk_bf16_f32 v107, v86, v87
    v_mfma_f32_32x32x16_bf16 v[64:79], v[148:151], v[216:219], v[64:79]
    v_exp_f32 v88, v88
    v_exp_f32 v89, v89
    v_exp_f32 v90, v90
    v_exp_f32 v91, v91
    v_cvt_pk_bf16_f32 v108, v88, v89
    v_cvt_pk_bf16_f32 v109, v90, v91
    v_mfma_f32_32x32x16_bf16 v[128:143], v[164:167], v[104:107], v[128:143]
    v_exp_f32 v92, v92
    v_exp_f32 v93, v93
    v_exp_f32 v94, v94
    v_exp_f32 v95, v95
    v_cvt_pk_bf16_f32 v102, v60, v61
    v_cvt_pk_bf16_f32 v103, v62, v63
    s_waitcnt lgkmcnt(0)
    v_mfma_f32_32x32x16_bf16 v[48:63], v[152:155], v[204:207], 0
    v_exp_f32 v32, v32
    v_exp_f32 v33, v33
    v_exp_f32 v34, v34
    v_exp_f32 v35, v35
    v_cvt_pk_bf16_f32 v96, v32, v33
    v_cvt_pk_bf16_f32 v97, v34, v35
    v_mfma_f32_32x32x16_bf16 v[112:127], v[172:175], v[100:103], v[112:127]
    v_exp_f32 v36, v36
    v_exp_f32 v37, v37
    v_exp_f32 v38, v38
    v_exp_f32 v39, v39
    v_cvt_pk_bf16_f32 v98, v36, v37
    v_cvt_pk_bf16_f32 v99, v38, v39
    v_mfma_f32_32x32x16_bf16 v[48:63], v[156:159], v[208:211], v[48:63]
    s_barrier
    ds_read_b128 v[144:147], v198 offset:32768
    ds_read_b128 v[148:151], v198 offset:33792
    ds_read_b128 v[164:167], v198 offset:14336
    ds_read_b128 v[168:171], v198 offset:11264
    v_exp_f32 v40, v40
    v_exp_f32 v41, v41
    v_exp_f32 v42, v42
    v_exp_f32 v43, v43
    v_cvt_pk_bf16_f32 v100, v40, v41
    v_cvt_pk_bf16_f32 v101, v42, v43
    v_mfma_f32_32x32x16_bf16 v[112:127], v[160:163], v[96:99], v[112:127]
    v_exp_f32 v44, v44
    v_exp_f32 v45, v45
    v_exp_f32 v46, v46
    v_exp_f32 v47, v47
    v_cvt_pk_bf16_f32 v110, v92, v93
    v_cvt_pk_bf16_f32 v111, v94, v95
    v_mfma_f32_32x32x16_bf16 v[80:95], v[152:155], v[212:215], 0
    v_exp_f32 v64, v64
    v_exp_f32 v65, v65
    v_exp_f32 v66, v66
    v_exp_f32 v67, v67
    v_cvt_pk_bf16_f32 v104, v64, v65
    v_cvt_pk_bf16_f32 v105, v66, v67
    v_mfma_f32_32x32x16_bf16 v[128:143], v[172:175], v[108:111], v[128:143]
    v_exp_f32 v68, v68
    v_exp_f32 v69, v69
    v_exp_f32 v70, v70
    v_exp_f32 v71, v71
    v_cvt_pk_bf16_f32 v106, v68, v69
    v_cvt_pk_bf16_f32 v107, v70, v71
    v_mfma_f32_32x32x16_bf16 v[80:95], v[156:159], v[216:219], v[80:95]
    v_exp_f32 v72, v72
    v_exp_f32 v73, v73
    v_exp_f32 v74, v74
    v_exp_f32 v75, v75
    v_cvt_pk_bf16_f32 v108, v72, v73
    v_cvt_pk_bf16_f32 v109, v74, v75
    v_mfma_f32_32x32x16_bf16 v[128:143], v[160:163], v[104:107], v[128:143]
    v_exp_f32 v76, v76
    v_exp_f32 v77, v77
    v_exp_f32 v78, v78
    v_exp_f32 v79, v79
    v_cvt_pk_bf16_f32 v102, v44, v45
    v_cvt_pk_bf16_f32 v103, v46, v47
    s_waitcnt lgkmcnt(0)
    v_mfma_f32_32x32x16_bf16 v[32:47], v[144:147], v[204:207], 0
    v_exp_f32 v48, v48
    v_exp_f32 v49, v49
    v_exp_f32 v50, v50
    v_exp_f32 v51, v51
    v_cvt_pk_bf16_f32 v96, v48, v49
    v_cvt_pk_bf16_f32 v97, v50, v51
    v_mfma_f32_32x32x16_bf16 v[112:127], v[168:171], v[100:103], v[112:127]
    v_exp_f32 v52, v52
    v_exp_f32 v53, v53
    v_exp_f32 v54, v54
    v_exp_f32 v55, v55
    v_cvt_pk_bf16_f32 v98, v52, v53
    v_cvt_pk_bf16_f32 v99, v54, v55
    v_mfma_f32_32x32x16_bf16 v[32:47], v[148:151], v[208:211], v[32:47]
    ds_read_b128 v[152:155], v198 offset:36864
    ds_read_b128 v[156:159], v198 offset:37888
    ds_read_b128 v[160:163], v198 offset:34816
    ds_read_b128 v[172:175], v198 offset:15360
    v_exp_f32 v56, v56
    v_exp_f32 v57, v57
    v_exp_f32 v58, v58
    v_exp_f32 v59, v59
    v_cvt_pk_bf16_f32 v100, v56, v57
    v_cvt_pk_bf16_f32 v101, v58, v59
    v_mfma_f32_32x32x16_bf16 v[112:127], v[164:167], v[96:99], v[112:127]
    v_exp_f32 v60, v60
    v_exp_f32 v61, v61
    v_exp_f32 v62, v62
    v_exp_f32 v63, v63
    v_cvt_pk_bf16_f32 v110, v76, v77
    v_cvt_pk_bf16_f32 v111, v78, v79
    v_mfma_f32_32x32x16_bf16 v[64:79], v[144:147], v[212:215], 0
    v_exp_f32 v80, v80
    v_exp_f32 v81, v81
    v_exp_f32 v82, v82
    v_exp_f32 v83, v83
    v_cvt_pk_bf16_f32 v104, v80, v81
    v_cvt_pk_bf16_f32 v105, v82, v83
    v_mfma_f32_32x32x16_bf16 v[128:143], v[168:171], v[108:111], v[128:143]
    v_exp_f32 v84, v84
    v_exp_f32 v85, v85
    v_exp_f32 v86, v86
    v_exp_f32 v87, v87
    v_cvt_pk_bf16_f32 v106, v84, v85
    v_cvt_pk_bf16_f32 v107, v86, v87
    v_mfma_f32_32x32x16_bf16 v[64:79], v[148:151], v[216:219], v[64:79]
    v_exp_f32 v88, v88
    v_exp_f32 v89, v89
    v_exp_f32 v90, v90
    v_exp_f32 v91, v91
    v_cvt_pk_bf16_f32 v108, v88, v89
    v_cvt_pk_bf16_f32 v109, v90, v91
    v_mfma_f32_32x32x16_bf16 v[128:143], v[164:167], v[104:107], v[128:143]
    v_exp_f32 v92, v92
    v_exp_f32 v93, v93
    v_exp_f32 v94, v94
    v_exp_f32 v95, v95
    v_cvt_pk_bf16_f32 v102, v60, v61
    v_cvt_pk_bf16_f32 v103, v62, v63
    s_waitcnt lgkmcnt(0)
    v_mfma_f32_32x32x16_bf16 v[48:63], v[152:155], v[204:207], 0
    v_exp_f32 v32, v32
    v_exp_f32 v33, v33
    v_exp_f32 v34, v34
    v_exp_f32 v35, v35
    v_cvt_pk_bf16_f32 v96, v32, v33
    v_cvt_pk_bf16_f32 v97, v34, v35
    v_mfma_f32_32x32x16_bf16 v[112:127], v[172:175], v[100:103], v[112:127]
    v_exp_f32 v36, v36
    v_exp_f32 v37, v37
    v_exp_f32 v38, v38
    v_exp_f32 v39, v39
    v_cvt_pk_bf16_f32 v98, v36, v37
    v_cvt_pk_bf16_f32 v99, v38, v39
    v_mfma_f32_32x32x16_bf16 v[48:63], v[156:159], v[208:211], v[48:63]
    ds_read_b128 v[144:147], v198 offset:40960
    ds_read_b128 v[148:151], v198 offset:41984
    ds_read_b128 v[164:167], v198 offset:38912
    ds_read_b128 v[168:171], v198 offset:35840
    v_exp_f32 v40, v40
    v_exp_f32 v41, v41
    v_exp_f32 v42, v42
    v_exp_f32 v43, v43
    v_cvt_pk_bf16_f32 v100, v40, v41
    v_cvt_pk_bf16_f32 v101, v42, v43
    v_mfma_f32_32x32x16_bf16 v[112:127], v[160:163], v[96:99], v[112:127]
    v_exp_f32 v44, v44
    v_exp_f32 v45, v45
    v_exp_f32 v46, v46
    v_exp_f32 v47, v47
    v_cvt_pk_bf16_f32 v110, v92, v93
    v_cvt_pk_bf16_f32 v111, v94, v95
    v_mfma_f32_32x32x16_bf16 v[80:95], v[152:155], v[212:215], 0
    v_exp_f32 v64, v64
    v_exp_f32 v65, v65
    v_exp_f32 v66, v66
    v_exp_f32 v67, v67
    v_cvt_pk_bf16_f32 v104, v64, v65
    v_cvt_pk_bf16_f32 v105, v66, v67
    v_mfma_f32_32x32x16_bf16 v[128:143], v[172:175], v[108:111], v[128:143]
    v_exp_f32 v68, v68
    v_exp_f32 v69, v69
    v_exp_f32 v70, v70
    v_exp_f32 v71, v71
    v_cvt_pk_bf16_f32 v106, v68, v69
    v_cvt_pk_bf16_f32 v107, v70, v71
    v_mfma_f32_32x32x16_bf16 v[80:95], v[156:159], v[216:219], v[80:95]
    v_exp_f32 v72, v72
    v_exp_f32 v73, v73
    v_exp_f32 v74, v74
    v_exp_f32 v75, v75
    v_cvt_pk_bf16_f32 v108, v72, v73
    v_cvt_pk_bf16_f32 v109, v74, v75
    v_mfma_f32_32x32x16_bf16 v[128:143], v[160:163], v[104:107], v[128:143]
    v_exp_f32 v76, v76
    v_exp_f32 v77, v77
    v_exp_f32 v78, v78
    v_exp_f32 v79, v79
    v_cvt_pk_bf16_f32 v102, v44, v45
    v_cvt_pk_bf16_f32 v103, v46, v47
    s_waitcnt lgkmcnt(0)
    v_mfma_f32_32x32x16_bf16 v[32:47], v[144:147], v[204:207], 0
    v_exp_f32 v48, v48
    v_exp_f32 v49, v49
    v_exp_f32 v50, v50
    v_exp_f32 v51, v51
    v_cvt_pk_bf16_f32 v96, v48, v49
    v_cvt_pk_bf16_f32 v97, v50, v51
    v_mfma_f32_32x32x16_bf16 v[112:127], v[168:171], v[100:103], v[112:127]
    v_exp_f32 v52, v52
    v_exp_f32 v53, v53
    v_exp_f32 v54, v54
    v_exp_f32 v55, v55
    v_cvt_pk_bf16_f32 v98, v52, v53
    v_cvt_pk_bf16_f32 v99, v54, v55
    v_mfma_f32_32x32x16_bf16 v[32:47], v[148:151], v[208:211], v[32:47]
    ds_read_b128 v[152:155], v198 offset:45056
    ds_read_b128 v[156:159], v198 offset:46080
    ds_read_b128 v[160:163], v198 offset:43008
    ds_read_b128 v[172:175], v198 offset:39936
    v_exp_f32 v56, v56
    v_exp_f32 v57, v57
    v_exp_f32 v58, v58
    v_exp_f32 v59, v59
    v_cvt_pk_bf16_f32 v100, v56, v57
    v_cvt_pk_bf16_f32 v101, v58, v59
    v_mfma_f32_32x32x16_bf16 v[112:127], v[164:167], v[96:99], v[112:127]
    v_exp_f32 v60, v60
    v_exp_f32 v61, v61
    v_exp_f32 v62, v62
    v_exp_f32 v63, v63
    v_cvt_pk_bf16_f32 v110, v76, v77
    v_cvt_pk_bf16_f32 v111, v78, v79
    v_mfma_f32_32x32x16_bf16 v[64:79], v[144:147], v[212:215], 0
    v_exp_f32 v80, v80
    v_exp_f32 v81, v81
    v_exp_f32 v82, v82
    v_exp_f32 v83, v83
    v_cvt_pk_bf16_f32 v104, v80, v81
    v_cvt_pk_bf16_f32 v105, v82, v83
    v_mfma_f32_32x32x16_bf16 v[128:143], v[168:171], v[108:111], v[128:143]
    v_exp_f32 v84, v84
    v_exp_f32 v85, v85
    v_exp_f32 v86, v86
    v_exp_f32 v87, v87
    v_cvt_pk_bf16_f32 v106, v84, v85
    v_cvt_pk_bf16_f32 v107, v86, v87
    v_mfma_f32_32x32x16_bf16 v[64:79], v[148:151], v[216:219], v[64:79]
    v_exp_f32 v88, v88
    v_exp_f32 v89, v89
    v_exp_f32 v90, v90
    v_exp_f32 v91, v91
    v_cvt_pk_bf16_f32 v108, v88, v89
    v_cvt_pk_bf16_f32 v109, v90, v91
    v_mfma_f32_32x32x16_bf16 v[128:143], v[164:167], v[104:107], v[128:143]
    v_exp_f32 v92, v92
    v_exp_f32 v93, v93
    v_exp_f32 v94, v94
    v_exp_f32 v95, v95
    v_cvt_pk_bf16_f32 v102, v60, v61
    v_cvt_pk_bf16_f32 v103, v62, v63
    s_waitcnt lgkmcnt(0)
    v_mfma_f32_32x32x16_bf16 v[48:63], v[152:155], v[204:207], 0
    v_exp_f32 v32, v32
    v_exp_f32 v33, v33
    v_exp_f32 v34, v34
    v_exp_f32 v35, v35
    v_cvt_pk_bf16_f32 v96, v32, v33
    v_cvt_pk_bf16_f32 v97, v34, v35
    v_mfma_f32_32x32x16_bf16 v[112:127], v[172:175], v[100:103], v[112:127]
    v_exp_f32 v36, v36
    v_exp_f32 v37, v37
    v_exp_f32 v38, v38
    v_exp_f32 v39, v39
    v_cvt_pk_bf16_f32 v98, v36, v37
    v_cvt_pk_bf16_f32 v99, v38, v39
    v_mfma_f32_32x32x16_bf16 v[48:63], v[156:159], v[208:211], v[48:63]
    s_barrier
    ds_read_b128 v[144:147], v199 offset:0
    ds_read_b128 v[148:151], v199 offset:1024
    ds_read_b128 v[164:167], v198 offset:47104
    ds_read_b128 v[168:171], v198 offset:44032
    v_exp_f32 v40, v40
    v_exp_f32 v41, v41
    v_exp_f32 v42, v42
    v_exp_f32 v43, v43
    v_cvt_pk_bf16_f32 v100, v40, v41
    v_cvt_pk_bf16_f32 v101, v42, v43
    v_mfma_f32_32x32x16_bf16 v[112:127], v[160:163], v[96:99], v[112:127]
    v_exp_f32 v44, v44
    v_exp_f32 v45, v45
    v_exp_f32 v46, v46
    v_exp_f32 v47, v47
    v_cvt_pk_bf16_f32 v110, v92, v93
    v_cvt_pk_bf16_f32 v111, v94, v95
    v_mfma_f32_32x32x16_bf16 v[80:95], v[152:155], v[212:215], 0
    v_exp_f32 v64, v64
    v_exp_f32 v65, v65
    v_exp_f32 v66, v66
    v_exp_f32 v67, v67
    v_cvt_pk_bf16_f32 v104, v64, v65
    v_cvt_pk_bf16_f32 v105, v66, v67
    v_mfma_f32_32x32x16_bf16 v[128:143], v[172:175], v[108:111], v[128:143]
    v_exp_f32 v68, v68
    v_exp_f32 v69, v69
    v_exp_f32 v70, v70
    v_exp_f32 v71, v71
    v_cvt_pk_bf16_f32 v106, v68, v69
    v_cvt_pk_bf16_f32 v107, v70, v71
    v_mfma_f32_32x32x16_bf16 v[80:95], v[156:159], v[216:219], v[80:95]
    v_exp_f32 v72, v72
    v_exp_f32 v73, v73
    v_exp_f32 v74, v74
    v_exp_f32 v75, v75
    v_cvt_pk_bf16_f32 v108, v72, v73
    v_cvt_pk_bf16_f32 v109, v74, v75
    v_mfma_f32_32x32x16_bf16 v[128:143], v[160:163], v[104:107], v[128:143]
    v_exp_f32 v76, v76
    v_exp_f32 v77, v77
    v_exp_f32 v78, v78
    v_exp_f32 v79, v79
    v_cvt_pk_bf16_f32 v102, v44, v45
    v_cvt_pk_bf16_f32 v103, v46, v47
    s_waitcnt lgkmcnt(0)
    v_mfma_f32_32x32x16_bf16 v[32:47], v[144:147], v[204:207], 0
    v_exp_f32 v48, v48
    v_exp_f32 v49, v49
    v_exp_f32 v50, v50
    v_exp_f32 v51, v51
    v_cvt_pk_bf16_f32 v96, v48, v49
    v_cvt_pk_bf16_f32 v97, v50, v51
    v_mfma_f32_32x32x16_bf16 v[112:127], v[168:171], v[100:103], v[112:127]
    v_exp_f32 v52, v52
    v_exp_f32 v53, v53
    v_exp_f32 v54, v54
    v_exp_f32 v55, v55
    v_cvt_pk_bf16_f32 v98, v52, v53
    v_cvt_pk_bf16_f32 v99, v54, v55
    v_mfma_f32_32x32x16_bf16 v[32:47], v[148:151], v[208:211], v[32:47]
    ds_read_b128 v[152:155], v199 offset:4096
    ds_read_b128 v[156:159], v199 offset:5120
    ds_read_b128 v[160:163], v199 offset:2048
    ds_read_b128 v[172:175], v198 offset:48128
    v_exp_f32 v56, v56
    v_exp_f32 v57, v57
    v_exp_f32 v58, v58
    v_exp_f32 v59, v59
    v_cvt_pk_bf16_f32 v100, v56, v57
    v_cvt_pk_bf16_f32 v101, v58, v59
    v_mfma_f32_32x32x16_bf16 v[112:127], v[164:167], v[96:99], v[112:127]
    v_exp_f32 v60, v60
    v_exp_f32 v61, v61
    v_exp_f32 v62, v62
    v_exp_f32 v63, v63
    v_cvt_pk_bf16_f32 v110, v76, v77
    v_cvt_pk_bf16_f32 v111, v78, v79
    v_mfma_f32_32x32x16_bf16 v[64:79], v[144:147], v[212:215], 0
    v_exp_f32 v80, v80
    v_exp_f32 v81, v81
    v_exp_f32 v82, v82
    v_exp_f32 v83, v83
    v_cvt_pk_bf16_f32 v104, v80, v81
    v_cvt_pk_bf16_f32 v105, v82, v83
    v_mfma_f32_32x32x16_bf16 v[128:143], v[168:171], v[108:111], v[128:143]
    v_exp_f32 v84, v84
    v_exp_f32 v85, v85
    v_exp_f32 v86, v86
    v_exp_f32 v87, v87
    v_cvt_pk_bf16_f32 v106, v84, v85
    v_cvt_pk_bf16_f32 v107, v86, v87
    v_mfma_f32_32x32x16_bf16 v[64:79], v[148:151], v[216:219], v[64:79]
    v_exp_f32 v88, v88
    v_exp_f32 v89, v89
    v_exp_f32 v90, v90
    v_exp_f32 v91, v91
    v_cvt_pk_bf16_f32 v108, v88, v89
    v_cvt_pk_bf16_f32 v109, v90, v91
    v_mfma_f32_32x32x16_bf16 v[128:143], v[164:167], v[104:107], v[128:143]
    v_exp_f32 v92, v92
    v_exp_f32 v93, v93
    v_exp_f32 v94, v94
    v_exp_f32 v95, v95
    v_cvt_pk_bf16_f32 v102, v60, v61
    v_cvt_pk_bf16_f32 v103, v62, v63
    s_waitcnt lgkmcnt(0)
    v_mfma_f32_32x32x16_bf16 v[48:63], v[152:155], v[204:207], 0
    v_exp_f32 v32, v32
    v_exp_f32 v33, v33
    v_exp_f32 v34, v34
    v_exp_f32 v35, v35
    v_cvt_pk_bf16_f32 v96, v32, v33
    v_cvt_pk_bf16_f32 v97, v34, v35
    v_mfma_f32_32x32x16_bf16 v[112:127], v[172:175], v[100:103], v[112:127]
    v_exp_f32 v36, v36
    v_exp_f32 v37, v37
    v_exp_f32 v38, v38
    v_exp_f32 v39, v39
    v_cvt_pk_bf16_f32 v98, v36, v37
    v_cvt_pk_bf16_f32 v99, v38, v39
    v_mfma_f32_32x32x16_bf16 v[48:63], v[156:159], v[208:211], v[48:63]
    ds_read_b128 v[144:147], v199 offset:8192
    ds_read_b128 v[148:151], v199 offset:9216
    ds_read_b128 v[164:167], v199 offset:6144
    ds_read_b128 v[168:171], v199 offset:3072
    v_exp_f32 v40, v40
    v_exp_f32 v41, v41
    v_exp_f32 v42, v42
    v_exp_f32 v43, v43
    v_cvt_pk_bf16_f32 v100, v40, v41
    v_cvt_pk_bf16_f32 v101, v42, v43
    v_mfma_f32_32x32x16_bf16 v[112:127], v[160:163], v[96:99], v[112:127]
    v_exp_f32 v44, v44
    v_exp_f32 v45, v45
    v_exp_f32 v46, v46
    v_exp_f32 v47, v47
    v_cvt_pk_bf16_f32 v110, v92, v93
    v_cvt_pk_bf16_f32 v111, v94, v95
    v_mfma_f32_32x32x16_bf16 v[80:95], v[152:155], v[212:215], 0
    v_exp_f32 v64, v64
    v_exp_f32 v65, v65
    v_exp_f32 v66, v66
    v_exp_f32 v67, v67
    v_cvt_pk_bf16_f32 v104, v64, v65
    v_cvt_pk_bf16_f32 v105, v66, v67
    v_mfma_f32_32x32x16_bf16 v[128:143], v[172:175], v[108:111], v[128:143]
    v_exp_f32 v68, v68
    v_exp_f32 v69, v69
    v_exp_f32 v70, v70
    v_exp_f32 v71, v71
    v_cvt_pk_bf16_f32 v106, v68, v69
    v_cvt_pk_bf16_f32 v107, v70, v71
    v_mfma_f32_32x32x16_bf16 v[80:95], v[156:159], v[216:219], v[80:95]
    v_exp_f32 v72, v72
    v_exp_f32 v73, v73
    v_exp_f32 v74, v74
    v_exp_f32 v75, v75
    v_cvt_pk_bf16_f32 v108, v72, v73
    v_cvt_pk_bf16_f32 v109, v74, v75
    v_mfma_f32_32x32x16_bf16 v[128:143], v[160:163], v[104:107], v[128:143]
    v_exp_f32 v76, v76
    v_exp_f32 v77, v77
    v_exp_f32 v78, v78
    v_exp_f32 v79, v79
    v_cvt_pk_bf16_f32 v102, v44, v45
    v_cvt_pk_bf16_f32 v103, v46, v47
    s_waitcnt lgkmcnt(0)
    v_mfma_f32_32x32x16_bf16 v[32:47], v[144:147], v[204:207], 0
    v_exp_f32 v48, v48
    v_exp_f32 v49, v49
    v_exp_f32 v50, v50
    v_exp_f32 v51, v51
    v_cvt_pk_bf16_f32 v96, v48, v49
    v_cvt_pk_bf16_f32 v97, v50, v51
    v_mfma_f32_32x32x16_bf16 v[112:127], v[168:171], v[100:103], v[112:127]
    v_exp_f32 v52, v52
    v_exp_f32 v53, v53
    v_exp_f32 v54, v54
    v_exp_f32 v55, v55
    v_cvt_pk_bf16_f32 v98, v52, v53
    v_cvt_pk_bf16_f32 v99, v54, v55
    v_mfma_f32_32x32x16_bf16 v[32:47], v[148:151], v[208:211], v[32:47]
    ds_read_b128 v[152:155], v199 offset:12288
    ds_read_b128 v[156:159], v199 offset:13312
    ds_read_b128 v[160:163], v199 offset:10240
    ds_read_b128 v[172:175], v199 offset:7168
    v_exp_f32 v56, v56
    v_exp_f32 v57, v57
    v_exp_f32 v58, v58
    v_exp_f32 v59, v59
    v_cvt_pk_bf16_f32 v100, v56, v57
    v_cvt_pk_bf16_f32 v101, v58, v59
    v_mfma_f32_32x32x16_bf16 v[112:127], v[164:167], v[96:99], v[112:127]
    v_exp_f32 v60, v60
    v_exp_f32 v61, v61
    v_exp_f32 v62, v62
    v_exp_f32 v63, v63
    v_cvt_pk_bf16_f32 v110, v76, v77
    v_cvt_pk_bf16_f32 v111, v78, v79
    v_mfma_f32_32x32x16_bf16 v[64:79], v[144:147], v[212:215], 0
    v_exp_f32 v80, v80
    v_exp_f32 v81, v81
    v_exp_f32 v82, v82
    v_exp_f32 v83, v83
    v_cvt_pk_bf16_f32 v104, v80, v81
    v_cvt_pk_bf16_f32 v105, v82, v83
    v_mfma_f32_32x32x16_bf16 v[128:143], v[168:171], v[108:111], v[128:143]
    v_exp_f32 v84, v84
    v_exp_f32 v85, v85
    v_exp_f32 v86, v86
    v_exp_f32 v87, v87
    v_cvt_pk_bf16_f32 v106, v84, v85
    v_cvt_pk_bf16_f32 v107, v86, v87
    v_mfma_f32_32x32x16_bf16 v[64:79], v[148:151], v[216:219], v[64:79]
    v_exp_f32 v88, v88
    v_exp_f32 v89, v89
    v_exp_f32 v90, v90
    v_exp_f32 v91, v91
    v_cvt_pk_bf16_f32 v108, v88, v89
    v_cvt_pk_bf16_f32 v109, v90, v91
    v_mfma_f32_32x32x16_bf16 v[128:143], v[164:167], v[104:107], v[128:143]
    v_exp_f32 v92, v92
    v_exp_f32 v93, v93
    v_exp_f32 v94, v94
    v_exp_f32 v95, v95
    v_cvt_pk_bf16_f32 v102, v60, v61
    v_cvt_pk_bf16_f32 v103, v62, v63
    s_waitcnt lgkmcnt(0)
    v_mfma_f32_32x32x16_bf16 v[48:63], v[152:155], v[204:207], 0
    v_exp_f32 v32, v32
    v_exp_f32 v33, v33
    v_exp_f32 v34, v34
    v_exp_f32 v35, v35
    v_cvt_pk_bf16_f32 v96, v32, v33
    v_cvt_pk_bf16_f32 v97, v34, v35
    v_mfma_f32_32x32x16_bf16 v[112:127], v[172:175], v[100:103], v[112:127]
    v_exp_f32 v36, v36
    v_exp_f32 v37, v37
    v_exp_f32 v38, v38
    v_exp_f32 v39, v39
    v_cvt_pk_bf16_f32 v98, v36, v37
    v_cvt_pk_bf16_f32 v99, v38, v39
    v_mfma_f32_32x32x16_bf16 v[48:63], v[156:159], v[208:211], v[48:63]
    s_barrier
    ds_read_b128 v[144:147], v199 offset:32768
    ds_read_b128 v[148:151], v199 offset:33792
    ds_read_b128 v[164:167], v199 offset:14336
    ds_read_b128 v[168:171], v199 offset:11264
    v_exp_f32 v40, v40
    v_exp_f32 v41, v41
    v_exp_f32 v42, v42
    v_exp_f32 v43, v43
    v_cvt_pk_bf16_f32 v100, v40, v41
    v_cvt_pk_bf16_f32 v101, v42, v43
    v_mfma_f32_32x32x16_bf16 v[112:127], v[160:163], v[96:99], v[112:127]
    v_exp_f32 v44, v44
    v_exp_f32 v45, v45
    v_exp_f32 v46, v46
    v_exp_f32 v47, v47
    v_cvt_pk_bf16_f32 v110, v92, v93
    v_cvt_pk_bf16_f32 v111, v94, v95
    v_mfma_f32_32x32x16_bf16 v[80:95], v[152:155], v[212:215], 0
    v_exp_f32 v64, v64
    v_exp_f32 v65, v65
    v_exp_f32 v66, v66
    v_exp_f32 v67, v67
    v_cvt_pk_bf16_f32 v104, v64, v65
    v_cvt_pk_bf16_f32 v105, v66, v67
    v_mfma_f32_32x32x16_bf16 v[128:143], v[172:175], v[108:111], v[128:143]
    v_exp_f32 v68, v68
    v_exp_f32 v69, v69
    v_exp_f32 v70, v70
    v_exp_f32 v71, v71
    v_cvt_pk_bf16_f32 v106, v68, v69
    v_cvt_pk_bf16_f32 v107, v70, v71
    v_mfma_f32_32x32x16_bf16 v[80:95], v[156:159], v[216:219], v[80:95]
    v_exp_f32 v72, v72
    v_exp_f32 v73, v73
    v_exp_f32 v74, v74
    v_exp_f32 v75, v75
    v_cvt_pk_bf16_f32 v108, v72, v73
    v_cvt_pk_bf16_f32 v109, v74, v75
    v_mfma_f32_32x32x16_bf16 v[128:143], v[160:163], v[104:107], v[128:143]
    v_exp_f32 v76, v76
    v_exp_f32 v77, v77
    v_exp_f32 v78, v78
    v_exp_f32 v79, v79
    v_cvt_pk_bf16_f32 v102, v44, v45
    v_cvt_pk_bf16_f32 v103, v46, v47
    s_waitcnt lgkmcnt(0)
    v_mfma_f32_32x32x16_bf16 v[32:47], v[144:147], v[204:207], 0
    v_exp_f32 v48, v48
    v_exp_f32 v49, v49
    v_exp_f32 v50, v50
    v_exp_f32 v51, v51
    v_cvt_pk_bf16_f32 v96, v48, v49
    v_cvt_pk_bf16_f32 v97, v50, v51
    v_mfma_f32_32x32x16_bf16 v[112:127], v[168:171], v[100:103], v[112:127]
    v_exp_f32 v52, v52
    v_exp_f32 v53, v53
    v_exp_f32 v54, v54
    v_exp_f32 v55, v55
    v_cvt_pk_bf16_f32 v98, v52, v53
    v_cvt_pk_bf16_f32 v99, v54, v55
    v_mfma_f32_32x32x16_bf16 v[32:47], v[148:151], v[208:211], v[32:47]
    ds_read_b128 v[152:155], v199 offset:36864
    ds_read_b128 v[156:159], v199 offset:37888
    ds_read_b128 v[160:163], v199 offset:34816
    ds_read_b128 v[172:175], v199 offset:15360
    v_exp_f32 v56, v56
    v_exp_f32 v57, v57
    v_exp_f32 v58, v58
    v_exp_f32 v59, v59
    v_cvt_pk_bf16_f32 v100, v56, v57
    v_cvt_pk_bf16_f32 v101, v58, v59
    v_mfma_f32_32x32x16_bf16 v[112:127], v[164:167], v[96:99], v[112:127]
    v_exp_f32 v60, v60
    v_exp_f32 v61, v61
    v_exp_f32 v62, v62
    v_exp_f32 v63, v63
    v_cvt_pk_bf16_f32 v110, v76, v77
    v_cvt_pk_bf16_f32 v111, v78, v79
    v_mfma_f32_32x32x16_bf16 v[64:79], v[144:147], v[212:215], 0
    v_exp_f32 v80, v80
    v_exp_f32 v81, v81
    v_exp_f32 v82, v82
    v_exp_f32 v83, v83
    v_cvt_pk_bf16_f32 v104, v80, v81
    v_cvt_pk_bf16_f32 v105, v82, v83
    v_mfma_f32_32x32x16_bf16 v[128:143], v[168:171], v[108:111], v[128:143]
    v_exp_f32 v84, v84
    v_exp_f32 v85, v85
    v_exp_f32 v86, v86
    v_exp_f32 v87, v87
    v_cvt_pk_bf16_f32 v106, v84, v85
    v_cvt_pk_bf16_f32 v107, v86, v87
    v_mfma_f32_32x32x16_bf16 v[64:79], v[148:151], v[216:219], v[64:79]
    v_exp_f32 v88, v88
    v_exp_f32 v89, v89
    v_exp_f32 v90, v90
    v_exp_f32 v91, v91
    v_cvt_pk_bf16_f32 v108, v88, v89
    v_cvt_pk_bf16_f32 v109, v90, v91
    v_mfma_f32_32x32x16_bf16 v[128:143], v[164:167], v[104:107], v[128:143]
    v_exp_f32 v92, v92
    v_exp_f32 v93, v93
    v_exp_f32 v94, v94
    v_exp_f32 v95, v95
    v_cvt_pk_bf16_f32 v102, v60, v61
    v_cvt_pk_bf16_f32 v103, v62, v63
    s_waitcnt lgkmcnt(0)
    v_mfma_f32_32x32x16_bf16 v[48:63], v[152:155], v[204:207], 0
    v_exp_f32 v32, v32
    v_exp_f32 v33, v33
    v_exp_f32 v34, v34
    v_exp_f32 v35, v35
    v_cvt_pk_bf16_f32 v96, v32, v33
    v_cvt_pk_bf16_f32 v97, v34, v35
    v_mfma_f32_32x32x16_bf16 v[112:127], v[172:175], v[100:103], v[112:127]
    v_exp_f32 v36, v36
    v_exp_f32 v37, v37
    v_exp_f32 v38, v38
    v_exp_f32 v39, v39
    v_cvt_pk_bf16_f32 v98, v36, v37
    v_cvt_pk_bf16_f32 v99, v38, v39
    v_mfma_f32_32x32x16_bf16 v[48:63], v[156:159], v[208:211], v[48:63]
    ds_read_b128 v[144:147], v199 offset:40960
    ds_read_b128 v[148:151], v199 offset:41984
    ds_read_b128 v[164:167], v199 offset:38912
    ds_read_b128 v[168:171], v199 offset:35840
    v_exp_f32 v40, v40
    v_exp_f32 v41, v41
    v_exp_f32 v42, v42
    v_exp_f32 v43, v43
    v_cvt_pk_bf16_f32 v100, v40, v41
    v_cvt_pk_bf16_f32 v101, v42, v43
    v_mfma_f32_32x32x16_bf16 v[112:127], v[160:163], v[96:99], v[112:127]
    v_exp_f32 v44, v44
    v_exp_f32 v45, v45
    v_exp_f32 v46, v46
    v_exp_f32 v47, v47
    v_cvt_pk_bf16_f32 v110, v92, v93
    v_cvt_pk_bf16_f32 v111, v94, v95
    v_mfma_f32_32x32x16_bf16 v[80:95], v[152:155], v[212:215], 0
    v_exp_f32 v64, v64
    v_exp_f32 v65, v65
    v_exp_f32 v66, v66
    v_exp_f32 v67, v67
    v_cvt_pk_bf16_f32 v104, v64, v65
    v_cvt_pk_bf16_f32 v105, v66, v67
    v_mfma_f32_32x32x16_bf16 v[128:143], v[172:175], v[108:111], v[128:143]
    v_exp_f32 v68, v68
    v_exp_f32 v69, v69
    v_exp_f32 v70, v70
    v_exp_f32 v71, v71
    v_cvt_pk_bf16_f32 v106, v68, v69
    v_cvt_pk_bf16_f32 v107, v70, v71
    v_mfma_f32_32x32x16_bf16 v[80:95], v[156:159], v[216:219], v[80:95]
    v_exp_f32 v72, v72
    v_exp_f32 v73, v73
    v_exp_f32 v74, v74
    v_exp_f32 v75, v75
    v_cvt_pk_bf16_f32 v108, v72, v73
    v_cvt_pk_bf16_f32 v109, v74, v75
    v_mfma_f32_32x32x16_bf16 v[128:143], v[160:163], v[104:107], v[128:143]
    v_exp_f32 v76, v76
    v_exp_f32 v77, v77
    v_exp_f32 v78, v78
    v_exp_f32 v79, v79
    v_cvt_pk_bf16_f32 v102, v44, v45
    v_cvt_pk_bf16_f32 v103, v46, v47
    s_waitcnt lgkmcnt(0)
    v_mfma_f32_32x32x16_bf16 v[32:47], v[144:147], v[204:207], 0
    v_exp_f32 v48, v48
    v_exp_f32 v49, v49
    v_exp_f32 v50, v50
    v_exp_f32 v51, v51
    v_cvt_pk_bf16_f32 v96, v48, v49
    v_cvt_pk_bf16_f32 v97, v50, v51
    v_mfma_f32_32x32x16_bf16 v[112:127], v[168:171], v[100:103], v[112:127]
    v_exp_f32 v52, v52
    v_exp_f32 v53, v53
    v_exp_f32 v54, v54
    v_exp_f32 v55, v55
    v_cvt_pk_bf16_f32 v98, v52, v53
    v_cvt_pk_bf16_f32 v99, v54, v55
    v_mfma_f32_32x32x16_bf16 v[32:47], v[148:151], v[208:211], v[32:47]
    ds_read_b128 v[152:155], v199 offset:45056
    ds_read_b128 v[156:159], v199 offset:46080
    ds_read_b128 v[160:163], v199 offset:43008
    ds_read_b128 v[172:175], v199 offset:39936
    v_exp_f32 v56, v56
    v_exp_f32 v57, v57
    v_exp_f32 v58, v58
    v_exp_f32 v59, v59
    v_cvt_pk_bf16_f32 v100, v56, v57
    v_cvt_pk_bf16_f32 v101, v58, v59
    v_mfma_f32_32x32x16_bf16 v[112:127], v[164:167], v[96:99], v[112:127]
    v_exp_f32 v60, v60
    v_exp_f32 v61, v61
    v_exp_f32 v62, v62
    v_exp_f32 v63, v63
    v_cvt_pk_bf16_f32 v110, v76, v77
    v_cvt_pk_bf16_f32 v111, v78, v79
    v_mfma_f32_32x32x16_bf16 v[64:79], v[144:147], v[212:215], 0
    v_exp_f32 v80, v80
    v_exp_f32 v81, v81
    v_exp_f32 v82, v82
    v_exp_f32 v83, v83
    v_cvt_pk_bf16_f32 v104, v80, v81
    v_cvt_pk_bf16_f32 v105, v82, v83
    v_mfma_f32_32x32x16_bf16 v[128:143], v[168:171], v[108:111], v[128:143]
    v_exp_f32 v84, v84
    v_exp_f32 v85, v85
    v_exp_f32 v86, v86
    v_exp_f32 v87, v87
    v_cvt_pk_bf16_f32 v106, v84, v85
    v_cvt_pk_bf16_f32 v107, v86, v87
    v_mfma_f32_32x32x16_bf16 v[64:79], v[148:151], v[216:219], v[64:79]
    v_exp_f32 v88, v88
    v_exp_f32 v89, v89
    v_exp_f32 v90, v90
    v_exp_f32 v91, v91
    v_cvt_pk_bf16_f32 v108, v88, v89
    v_cvt_pk_bf16_f32 v109, v90, v91
    v_mfma_f32_32x32x16_bf16 v[128:143], v[164:167], v[104:107], v[128:143]
    v_exp_f32 v92, v92
    v_exp_f32 v93, v93
    v_exp_f32 v94, v94
    v_exp_f32 v95, v95
    v_cvt_pk_bf16_f32 v102, v60, v61
    v_cvt_pk_bf16_f32 v103, v62, v63
    s_waitcnt lgkmcnt(0)
    v_mfma_f32_32x32x16_bf16 v[48:63], v[152:155], v[204:207], 0
    v_exp_f32 v32, v32
    v_exp_f32 v33, v33
    v_exp_f32 v34, v34
    v_exp_f32 v35, v35
    v_cvt_pk_bf16_f32 v96, v32, v33
    v_cvt_pk_bf16_f32 v97, v34, v35
    v_mfma_f32_32x32x16_bf16 v[112:127], v[172:175], v[100:103], v[112:127]
    v_exp_f32 v36, v36
    v_exp_f32 v37, v37
    v_exp_f32 v38, v38
    v_exp_f32 v39, v39
    v_cvt_pk_bf16_f32 v98, v36, v37
    v_cvt_pk_bf16_f32 v99, v38, v39
    v_mfma_f32_32x32x16_bf16 v[48:63], v[156:159], v[208:211], v[48:63]
    ds_read_b128 v[164:167], v199 offset:47104
    ds_read_b128 v[168:171], v199 offset:44032
    v_exp_f32 v40, v40
    v_exp_f32 v41, v41
    v_exp_f32 v42, v42
    v_exp_f32 v43, v43
    v_cvt_pk_bf16_f32 v100, v40, v41
    v_cvt_pk_bf16_f32 v101, v42, v43
    v_mfma_f32_32x32x16_bf16 v[112:127], v[160:163], v[96:99], v[112:127]
    v_exp_f32 v44, v44
    v_exp_f32 v45, v45
    v_exp_f32 v46, v46
    v_exp_f32 v47, v47
    v_cvt_pk_bf16_f32 v110, v92, v93
    v_cvt_pk_bf16_f32 v111, v94, v95
    v_mfma_f32_32x32x16_bf16 v[80:95], v[152:155], v[212:215], 0
    v_exp_f32 v64, v64
    v_exp_f32 v65, v65
    v_exp_f32 v66, v66
    v_exp_f32 v67, v67
    v_cvt_pk_bf16_f32 v104, v64, v65
    v_cvt_pk_bf16_f32 v105, v66, v67
    v_mfma_f32_32x32x16_bf16 v[128:143], v[172:175], v[108:111], v[128:143]
    v_exp_f32 v68, v68
    v_exp_f32 v69, v69
    v_exp_f32 v70, v70
    v_exp_f32 v71, v71
    v_cvt_pk_bf16_f32 v106, v68, v69
    v_cvt_pk_bf16_f32 v107, v70, v71
    v_mfma_f32_32x32x16_bf16 v[80:95], v[156:159], v[216:219], v[80:95]
    v_exp_f32 v72, v72
    v_exp_f32 v73, v73
    v_exp_f32 v74, v74
    v_exp_f32 v75, v75
    v_cvt_pk_bf16_f32 v108, v72, v73
    v_cvt_pk_bf16_f32 v109, v74, v75
    v_mfma_f32_32x32x16_bf16 v[128:143], v[160:163], v[104:107], v[128:143]
    v_exp_f32 v76, v76
    v_exp_f32 v77, v77
    v_exp_f32 v78, v78
    v_exp_f32 v79, v79
    v_cvt_pk_bf16_f32 v102, v44, v45
    v_cvt_pk_bf16_f32 v103, v46, v47
    s_waitcnt lgkmcnt(0)
    v_exp_f32 v48, v48
    v_exp_f32 v49, v49
    v_exp_f32 v50, v50
    v_exp_f32 v51, v51
    v_cvt_pk_bf16_f32 v96, v48, v49
    v_cvt_pk_bf16_f32 v97, v50, v51
    v_mfma_f32_32x32x16_bf16 v[112:127], v[168:171], v[100:103], v[112:127]
    v_exp_f32 v52, v52
    v_exp_f32 v53, v53
    v_exp_f32 v54, v54
    v_exp_f32 v55, v55
    v_cvt_pk_bf16_f32 v98, v52, v53
    v_cvt_pk_bf16_f32 v99, v54, v55
    ds_read_b128 v[172:175], v199 offset:48128
    v_exp_f32 v56, v56
    v_exp_f32 v57, v57
    v_exp_f32 v58, v58
    v_exp_f32 v59, v59
    v_cvt_pk_bf16_f32 v100, v56, v57
    v_cvt_pk_bf16_f32 v101, v58, v59
    v_mfma_f32_32x32x16_bf16 v[112:127], v[164:167], v[96:99], v[112:127]
    v_exp_f32 v60, v60
    v_exp_f32 v61, v61
    v_exp_f32 v62, v62
    v_exp_f32 v63, v63
    v_cvt_pk_bf16_f32 v110, v76, v77
    v_cvt_pk_bf16_f32 v111, v78, v79
    v_exp_f32 v80, v80
    v_exp_f32 v81, v81
    v_exp_f32 v82, v82
    v_exp_f32 v83, v83
    v_cvt_pk_bf16_f32 v104, v80, v81
    v_cvt_pk_bf16_f32 v105, v82, v83
    v_mfma_f32_32x32x16_bf16 v[128:143], v[168:171], v[108:111], v[128:143]
    v_exp_f32 v84, v84
    v_exp_f32 v85, v85
    v_exp_f32 v86, v86
    v_exp_f32 v87, v87
    v_cvt_pk_bf16_f32 v106, v84, v85
    v_cvt_pk_bf16_f32 v107, v86, v87
    v_exp_f32 v88, v88
    v_exp_f32 v89, v89
    v_exp_f32 v90, v90
    v_exp_f32 v91, v91
    v_cvt_pk_bf16_f32 v108, v88, v89
    v_cvt_pk_bf16_f32 v109, v90, v91
    v_mfma_f32_32x32x16_bf16 v[128:143], v[164:167], v[104:107], v[128:143]
    v_exp_f32 v92, v92
    v_exp_f32 v93, v93
    v_exp_f32 v94, v94
    v_exp_f32 v95, v95
    s_waitcnt lgkmcnt(0)
    v_cvt_pk_bf16_f32 v102, v60, v61
    v_cvt_pk_bf16_f32 v103, v62, v63
    v_cvt_pk_bf16_f32 v110, v92, v93
    v_cvt_pk_bf16_f32 v111, v94, v95
    v_mfma_f32_32x32x16_bf16 v[112:127], v[172:175], v[100:103], v[112:127]
    s_nop 0
    v_mfma_f32_32x32x16_bf16 v[128:143], v[172:175], v[108:111], v[128:143]
    s_branch L_attjoin_64
L_loader_63:
    s_sub_u32 s53, s3, 4
    s_lshl_b32 s67, s50, 6
    s_add_u32 s67, s67, s53
    s_lshl_b32 s67, s67, 12
    s_add_u32 s67, s67, 0
    v_lshl_add_u32 v195, v1, 4, s67
    s_lshl_b32 s57, s53, 12
    s_add_u32 m0, s57, 65536
    s_mov_b32 s58, 32768
    buffer_load_dwordx4 v195, s[4:7], s58 offen offset:0 sc1 lds
    buffer_load_dwordx4 v195, s[4:7], s58 offen offset:1024 sc1 lds
    buffer_load_dwordx4 v195, s[4:7], s58 offen offset:2048 sc1 lds
    buffer_load_dwordx4 v195, s[4:7], s58 offen offset:3072 sc1 lds
    s_add_u32 m0, s57, 81920
    s_mov_b32 s58, 163840
    buffer_load_dwordx4 v195, s[4:7], s58 offen offset:0 sc1 lds
    buffer_load_dwordx4 v195, s[4:7], s58 offen offset:1024 sc1 lds
    buffer_load_dwordx4 v195, s[4:7], s58 offen offset:2048 sc1 lds
    buffer_load_dwordx4 v195, s[4:7], s58 offen offset:3072 sc1 lds
    v_lshrrev_b32 v12, 2, v1
    v_mul_u32_u24 v12, 896, v12
    v_and_b32 v13, 3, v1
    v_lshl_add_u32 v12, v13, 4, v12
    s_mul_i32 s67, s53, 14336
    s_lshl_b32 s68, s65, 7
    s_add_u32 s67, s67, s68
    s_cmp_eq_u32 s66, 0
    s_cselect_b32 s67, 0x80000000, s67
    v_add_u32 v197, s67, v12
    v_lshrrev_b32 v4, 3, v1
    v_and_b32 v5, 7, v1
    v_xor_b32 v7, v5, v4
    v_mul_u32_u24 v6, 896, v4
    v_lshl_add_u32 v7, v7, 4, v6
    s_lshl_b32 s70, s64, 6
    s_lshl_b32 s71, s53, 4
    s_add_u32 s70, s70, s71
    s_mul_i32 s70, s70, 896
    s_lshl_b32 s71, s65, 7
    s_add_u32 s70, s70, s71
    v_add_u32 v190, s70, v7
    v_lshlrev_b32 v6, 12, v4
    v_lshl_add_u32 v6, v5, 4, v6
    s_lshl_b32 s70, s65, 6
    s_lshl_b32 s71, s53, 4
    s_add_u32 s70, s70, s71
    s_lshl_b32 s70, s70, 12
    s_lshl_b32 s71, s64, 7
    s_add_u32 s70, s70, s71
    s_add_u32 s70, s70, 9437184
    v_add_u32 v191, s70, v6
    s_lshl_b32 s70, s65, 7
    s_add_u32 s70, s70, 6619136
    v_mov_b32 v192, s70
    s_waitcnt vmcnt(8)
    s_barrier
    s_add_u32 m0, s57, 98304
    s_mov_b32 s58, 49152
    buffer_load_dwordx4 v195, s[4:7], s58 offen offset:0 sc1 lds
    buffer_load_dwordx4 v195, s[4:7], s58 offen offset:1024 sc1 lds
    buffer_load_dwordx4 v195, s[4:7], s58 offen offset:2048 sc1 lds
    buffer_load_dwordx4 v195, s[4:7], s58 offen offset:3072 sc1 lds
    s_add_u32 m0, s57, 114688
    s_mov_b32 s58, 180224
    buffer_load_dwordx4 v195, s[4:7], s58 offen offset:0 sc1 lds
    buffer_load_dwordx4 v195, s[4:7], s58 offen offset:1024 sc1 lds
    buffer_load_dwordx4 v195, s[4:7], s58 offen offset:2048 sc1 lds
    buffer_load_dwordx4 v195, s[4:7], s58 offen offset:3072 sc1 lds
    s_waitcnt vmcnt(8)
    s_barrier
    s_add_u32 m0, s57, 0
    s_mov_b32 s58, 65536
    buffer_load_dwordx4 v195, s[4:7], s58 offen offset:0 sc1 lds
    buffer_load_dwordx4 v195, s[4:7], s58 offen offset:1024 sc1 lds
    buffer_load_dwordx4 v195, s[4:7], s58 offen offset:2048 sc1 lds
    buffer_load_dwordx4 v195, s[4:7], s58 offen offset:3072 sc1 lds
    s_add_u32 m0, s57, 16384
    s_mov_b32 s58, 196608
    buffer_load_dwordx4 v195, s[4:7], s58 offen offset:0 sc1 lds
    buffer_load_dwordx4 v195, s[4:7], s58 offen offset:1024 sc1 lds
    buffer_load_dwordx4 v195, s[4:7], s58 offen offset:2048 sc1 lds
    buffer_load_dwordx4 v195, s[4:7], s58 offen offset:3072 sc1 lds
    s_waitcnt vmcnt(8)
    s_barrier
    s_add_u32 m0, s57, 32768
    s_mov_b32 s58, 81920
    buffer_load_dwordx4 v195, s[4:7], s58 offen offset:0 sc1 lds
    buffer_load_dwordx4 v195, s[4:7], s58 offen offset:1024 sc1 lds
    buffer_load_dwordx4 v195, s[4:7], s58 offen offset:2048 sc1 lds
    buffer_load_dwordx4 v195, s[4:7], s58 offen offset:3072 sc1 lds
    s_add_u32 m0, s57, 49152
    s_mov_b32 s58, 212992
    buffer_load_dwordx4 v195, s[4:7], s58 offen offset:0 sc1 lds
    buffer_load_dwordx4 v195, s[4:7], s58 offen offset:1024 sc1 lds
    buffer_load_dwordx4 v195, s[4:7], s58 offen offset:2048 sc1 lds
    buffer_load_dwordx4 v195, s[4:7], s58 offen offset:3072 sc1 lds
    s_waitcnt vmcnt(8)
    s_barrier
    s_add_u32 m0, s57, 65536
    s_mov_b32 s58, 98304
    buffer_load_dwordx4 v195, s[4:7], s58 offen offset:0 sc1 lds
    buffer_load_dwordx4 v195, s[4:7], s58 offen offset:1024 sc1 lds
    buffer_load_dwordx4 v195, s[4:7], s58 offen offset:2048 sc1 lds
    buffer_load_dwordx4 v195, s[4:7], s58 offen offset:3072 sc1 lds
    s_add_u32 m0, s57, 81920
    s_mov_b32 s58, 229376
    buffer_load_dwordx4 v195, s[4:7], s58 offen offset:0 sc1 lds
    buffer_load_dwordx4 v195, s[4:7], s58 offen offset:1024 sc1 lds
    buffer_load_dwordx4 v195, s[4:7], s58 offen offset:2048 sc1 lds
    buffer_load_dwordx4 v195, s[4:7], s58 offen offset:3072 sc1 lds
    s_waitcnt vmcnt(8)
    s_barrier
    buffer_load_dword v193, v192, s[4:7], 0 offen sc1
    s_add_u32 m0, s57, 98304
    s_mov_b32 s58, 114688
    buffer_load_dwordx4 v195, s[4:7], s58 offen offset:0 sc1 lds
    buffer_load_dwordx4 v195, s[4:7], s58 offen offset:1024 sc1 lds
    buffer_load_dwordx4 v195, s[4:7], s58 offen offset:2048 sc1 lds
    buffer_load_dwordx4 v195, s[4:7], s58 offen offset:3072 sc1 lds
    s_add_u32 m0, s57, 114688
    s_mov_b32 s58, 245760
    buffer_load_dwordx4 v195, s[4:7], s58 offen offset:0 sc1 lds
    buffer_load_dwordx4 v195, s[4:7], s58 offen offset:1024 sc1 lds
    buffer_load_dwordx4 v195, s[4:7], s58 offen offset:2048 sc1 lds
    buffer_load_dwordx4 v195, s[4:7], s58 offen offset:3072 sc1 lds
    s_waitcnt vmcnt(8)
    s_barrier
    s_cmp_eq_u32 s66, 0
    s_cbranch_scc1 L_noxz_69
    v_readfirstlane_b32 s70, v193
    s_nop 3
    s_cmp_ge_u32 s70, 128
    s_cbranch_scc1 L_zok_70
    s_lshl_b32 s70, s65, 7
    s_add_u32 s70, s70, 6619136
    v_mov_b32 v250, s70
    s_mov_b32 s74, 0
L_poll_71:
    buffer_load_dword v251, v250, s[4:7], 0 offen sc1
    s_waitcnt vmcnt(0)
    v_readfirstlane_b32 s75, v251
    s_add_u32 s74, s74, 1
    s_nop 2
    s_cmp_ge_u32 s75, 128
    s_cbranch_scc1 L_pollx_72
    s_cmp_ge_u32 s74, 65536
    s_cbranch_scc1 L_pollx_72
    s_sleep 1
    s_branch L_poll_71
L_pollx_72:
L_zok_70:
    s_lshl_b32 s70, s53, 11
    s_add_u32 m0, s70, 155648
    s_mov_b32 s71, 0
    buffer_load_dwordx4 v191, s[4:7], s71 offen sc1 lds
    s_add_u32 m0, s70, 156672
    s_mov_b32 s71, 32768
    buffer_load_dwordx4 v191, s[4:7], s71 offen sc1 lds
    s_add_u32 m0, s70, 147456
    s_mov_b32 s71, 0
    buffer_load_dwordx4 v190, s[8:11], s71 offen lds
    s_add_u32 m0, s70, 148480
    s_mov_b32 s71, 7168
    buffer_load_dwordx4 v190, s[8:11], s71 offen lds
L_noxz_69:
    s_lshl_b32 s72, s53, 10
    s_add_u32 m0, s72, 0
    s_mov_b32 s73, 0
    buffer_load_dwordx4 v197, s[32:35], s73 offen lds
    s_add_u32 m0, s72, 4096
    s_mov_b32 s73, 57344
    buffer_load_dwordx4 v197, s[32:35], s73 offen lds
    s_add_u32 m0, s72, 8192
    s_mov_b32 s73, 114688
    buffer_load_dwordx4 v197, s[32:35], s73 offen lds
    s_add_u32 m0, s72, 12288
    s_mov_b32 s73, 172032
    buffer_load_dwordx4 v197, s[32:35], s73 offen lds
    s_add_u32 m0, s72, 16384
    s_mov_b32 s73, 229376
    buffer_load_dwordx4 v197, s[32:35], s73 offen lds
    s_add_u32 m0, s72, 20480
    s_mov_b32 s73, 286720
    buffer_load_dwordx4 v197, s[32:35], s73 offen lds
    s_add_u32 m0, s72, 24576
    s_mov_b32 s73, 344064
    buffer_load_dwordx4 v197, s[32:35], s73 offen lds
    s_add_u32 m0, s72, 28672
    s_mov_b32 s73, 401408
    buffer_load_dwordx4 v197, s[32:35], s73 offen lds
    s_waitcnt vmcnt(8)
    s_barrier
    s_lshl_b32 s72, s53, 10
    s_add_u32 m0, s72, 32768
    s_mov_b32 s73, 64
    buffer_load_dwordx4 v197, s[32:35], s73 offen lds
    s_add_u32 m0, s72, 36864
    s_mov_b32 s73, 57408
    buffer_load_dwordx4 v197, s[32:35], s73 offen lds
    s_add_u32 m0, s72, 40960
    s_mov_b32 s73, 114752
    buffer_load_dwordx4 v197, s[32:35], s73 offen lds
    s_add_u32 m0, s72, 45056
    s_mov_b32 s73, 172096
    buffer_load_dwordx4 v197, s[32:35], s73 offen lds
    s_add_u32 m0, s72, 49152
    s_mov_b32 s73, 229440
    buffer_load_dwordx4 v197, s[32:35], s73 offen lds
    s_add_u32 m0, s72, 53248
    s_mov_b32 s73, 286784
    buffer_load_dwordx4 v197, s[32:35], s73 offen lds
    s_add_u32 m0, s72, 57344
    s_mov_b32 s73, 344128
    buffer_load_dwordx4 v197, s[32:35], s73 offen lds
    s_add_u32 m0, s72, 61440
    s_mov_b32 s73, 401472
    buffer_load_dwordx4 v197, s[32:35], s73 offen lds
L_attjoin_64:
    s_cmp_ge_u32 s3, 4
    s_cbranch_scc1 L_tailB_73
    s_lshl_b32 s67, s3, 12
    s_add_u32 s67, s67, 131072
    v_lshl_add_u32 v12, v1, 4, s67
    s_nop 5
    ds_write_b128 v12, v[128:131] offset:0
    ds_write_b128 v12, v[132:135] offset:1024
    ds_write_b128 v12, v[136:139] offset:2048
    ds_write_b128 v12, v[140:143] offset:3072
    s_xor_b32 s67, s3, 2
    s_lshl_b32 s67, s67, 12
    s_add_u32 s67, s67, 131072
    v_lshl_add_u32 v12, v1, 4, s67
    s_waitcnt lgkmcnt(0)
    s_barrier
    ds_read_b128 v[32:35], v12 offset:0
    ds_read_b128 v[36:39], v12 offset:1024
    ds_read_b128 v[40:43], v12 offset:2048
    ds_read_b128 v[44:47], v12 offset:3072
    s_lshl_b32 s67, s51, 2
    s_add_u32 s67, s67, s56
    s_lshl_b32 s68, s67, 4
    s_add_u32 s68, s68, s50
    s_lshl_b32 s68, s68, 11
    s_add_u32 s68, s68, 11534336
    v_lshl_add_u32 v14, v1, 4, s68
    s_waitcnt lgkmcnt(0)
    v_add_f32 v112, v112, v32
    v_add_f32 v113, v113, v33
    v_add_f32 v114, v114, v34
    v_add_f32 v115, v115, v35
    v_add_f32 v116, v116, v36
    v_add_f32 v117, v117, v37
    v_add_f32 v118, v118, v38
    v_add_f32 v119, v119, v39
    v_add_f32 v120, v120, v40
    v_add_f32 v121, v121, v41
    v_add_f32 v122, v122, v42
    v_add_f32 v123, v123, v43
    v_add_f32 v124, v124, v44
    v_add_f32 v125, v125, v45
    v_add_f32 v126, v126, v46
    v_add_f32 v127, v127, v47
    v_mov_b32 v12, v124
    v_mov_b32 v13, v124
    s_nop 1
    v_permlane32_swap_b32 v12, v13
    v_rcp_f32 v13, v13
    s_nop 0
    v_mul_f32 v112, v13, v112
    v_mul_f32 v113, v13, v113
    v_mul_f32 v114, v13, v114
    v_mul_f32 v115, v13, v115
    v_mul_f32 v116, v13, v116
    v_mul_f32 v117, v13, v117
    v_mul_f32 v118, v13, v118
    v_mul_f32 v119, v13, v119
    v_mul_f32 v120, v13, v120
    v_mul_f32 v121, v13, v121
    v_mul_f32 v122, v13, v122
    v_mul_f32 v123, v13, v123
    v_mul_f32 v124, v13, v124
    v_mul_f32 v125, v13, v125
    v_mul_f32 v126, v13, v126
    v_mul_f32 v127, v13, v127
    v_cvt_pk_bf16_f32 v96, v112, v113
    v_cvt_pk_bf16_f32 v97, v114, v115
    v_cvt_pk_bf16_f32 v98, v116, v117
    v_cvt_pk_bf16_f32 v99, v118, v119
    v_cvt_pk_bf16_f32 v100, v120, v121
    v_cvt_pk_bf16_f32 v101, v122, v123
    v_cvt_pk_bf16_f32 v102, v124, v125
    v_cvt_pk_bf16_f32 v103, v126, v127
    v_cndmask_b32 v102, v102, 0, s[62:63]
    v_cndmask_b32 v103, v103, 0, s[62:63]
    buffer_store_dwordx4 v[96:99], v14, s[4:7], 0 offen sc1
    buffer_store_dwordx4 v[100:103], v14, s[4:7], 0 offen offset:1024 sc1
    s_lshl_b32 s68, s51, 4
    s_add_u32 s68, s68, s50
    s_lshl_b32 s68, s68, 7
    s_add_u32 s68, s68, 6586368
    s_waitcnt vmcnt(0)
    s_barrier
    s_cmp_lg_u32 s3, 0
    s_cbranch_scc1 L_onl_75
    v_mov_b32 v250, s68
    v_mov_b32 v251, 1
    s_mov_b64 exec, 1
    buffer_store_dword v251, v250, s[4:7], 0 offen sc1
    s_mov_b64 exec, -1
L_onl_75:
    s_cmp_eq_u32 s66, 0
    s_cbranch_scc1 L_fin_74
    s_lshr_b32 s53, s3, 1
    s_and_b32 s54, s3, 1
    v_and_b32 v9, 31, v1
    s_lshl_b32 s55, s64, 6
    s_lshl_b32 s56, s53, 5
    s_add_u32 s55, s55, s56
    v_add_u32 v10, s55, v9
    v_lshrrev_b32 v13, 5, v1
    v_bfe_u32 v14, v1, 2, 2
    v_lshl_add_u32 v14, v13, 2, v14
    v_bfe_u32 v15, v1, 4, 1
    v_and_b32 v16, 3, v1
    v_lshlrev_b32 v17, 6, v14
    v_lshl_add_u32 v17, v15, 5, v17
    v_lshl_add_u32 v17, v16, 3, v17
    s_mul_i32 s55, s54, 32768
    s_add_u32 s55, s55, 0
    v_add_u32 v17, s55, v17
    s_lshl_b32 s55, s53, 15
    s_add_u32 s55, s55, 65536
    v_lshl_add_u32 v18, v1, 4, s55
    v_lshlrev_b32 v19, 7, v14
    v_lshl_add_u32 v19, v15, 5, v19
    v_lshl_add_u32 v19, v16, 3, v19
    s_lshl_b32 s55, s54, 12
    s_lshl_b32 s56, s53, 6
    s_add_u32 s55, s55, s56
    s_add_u32 s55, s55, 155648
    v_add_u32 v19, s55, v19
    s_lshl_b32 s55, s53, 12
    s_add_u32 s55, s55, 147456
    v_lshlrev_b32 v20, 7, v9
    v_lshl_add_u32 v20, v13, 3, v20
    v_add_u32 v20, s55, v20
    v_and_b32 v21, 7, v9
    s_lshl_b32 s55, s54, 2
    s_add_u32 s56, s55, 0
    v_xor_b32 v22, s56, v21
    v_lshl_add_u32 v22, v22, 4, v20
    s_add_u32 s56, s55, 1
    v_xor_b32 v23, s56, v21
    v_lshl_add_u32 v23, v23, 4, v20
    s_add_u32 s56, s55, 2
    v_xor_b32 v24, s56, v21
    v_lshl_add_u32 v24, v24, 4, v20
    s_add_u32 s56, s55, 3
    v_xor_b32 v25, s56, v21
    v_lshl_add_u32 v25, v25, 4, v20
    v_mul_u32_u24 v26, 896, v10
    v_lshl_add_u32 v26, v13, 4, v26
    s_lshl_b32 s55, s65, 7
    s_lshl_b32 s56, s54, 6
    s_add_u32 s55, s55, s56
    v_add_u32 v26, s55, v26
    s_lshl_b32 s55, s53, 7
    s_add_u32 s55, s55, 29184
    v_lshl_add_u32 v27, v9, 2, s55
    s_barrier
    s_lshr_b32 s56, s3, 2
    s_lshl_b32 s56, s56, 15
    s_and_b32 s57, s3, 3
    s_lshl_b32 s57, s57, 12
    s_add_u32 s57, s57, s56
    s_lshl_b32 s56, s64, 16
    s_add_u32 s56, s56, s57
    s_add_u32 s56, s56, 11534336
    v_lshlrev_b32 v2, 4, v1
    s_add_u32 m0, s57, 65536
    s_add_u32 s58, s56, 0
    buffer_load_dwordx4 v2, s[4:7], s58 offen offset:0 sc1 lds
    buffer_load_dwordx4 v2, s[4:7], s58 offen offset:1024 sc1 lds
    buffer_load_dwordx4 v2, s[4:7], s58 offen offset:2048 sc1 lds
    buffer_load_dwordx4 v2, s[4:7], s58 offen offset:3072 sc1 lds
    s_add_u32 m0, s57, 81920
    s_add_u32 s58, s56, 16384
    buffer_load_dwordx4 v2, s[4:7], s58 offen offset:0 sc1 lds
    buffer_load_dwordx4 v2, s[4:7], s58 offen offset:1024 sc1 lds
    buffer_load_dwordx4 v2, s[4:7], s58 offen offset:2048 sc1 lds
    buffer_load_dwordx4 v2, s[4:7], s58 offen offset:3072 sc1 lds
    s_waitcnt vmcnt(4)
    s_barrier
    ds_read_b32 v12, v27
    ds_read_b64_tr_b16 v[48:49], v17 offset:0
    ds_read_b64_tr_b16 v[50:51], v17 offset:512
    ds_read_b128 v[52:55], v18 offset:0
    ds_read_b64_tr_b16 v[56:57], v17 offset:1024
    ds_read_b64_tr_b16 v[58:59], v17 offset:1536
    ds_read_b128 v[60:63], v18 offset:1024
    ds_read_b64_tr_b16 v[64:65], v17 offset:1792
    ds_read_b64_tr_b16 v[66:67], v17 offset:2304
    ds_read_b128 v[68:71], v18 offset:2048
    s_waitcnt lgkmcnt(6)
    v_mfma_f32_32x32x16_bf16 v[32:47], v[48:51], v[52:55], 0
    ds_read_b64_tr_b16 v[48:49], v17 offset:2816
    ds_read_b64_tr_b16 v[50:51], v17 offset:3328
    ds_read_b128 v[52:55], v18 offset:3072
    s_waitcnt lgkmcnt(6)
    v_mfma_f32_32x32x16_bf16 v[32:47], v[56:59], v[60:63], v[32:47]
    ds_read_b64_tr_b16 v[56:57], v17 offset:3584
    ds_read_b64_tr_b16 v[58:59], v17 offset:4096
    ds_read_b128 v[60:63], v18 offset:4096
    s_waitcnt lgkmcnt(6)
    v_mfma_f32_32x32x16_bf16 v[32:47], v[64:67], v[68:71], v[32:47]
    ds_read_b64_tr_b16 v[64:65], v17 offset:4608
    ds_read_b64_tr_b16 v[66:67], v17 offset:5120
    ds_read_b128 v[68:71], v18 offset:5120
    s_waitcnt lgkmcnt(6)
    v_mfma_f32_32x32x16_bf16 v[32:47], v[48:51], v[52:55], v[32:47]
    ds_read_b64_tr_b16 v[48:49], v17 offset:5376
    ds_read_b64_tr_b16 v[50:51], v17 offset:5888
    ds_read_b128 v[52:55], v18 offset:6144
    s_waitcnt lgkmcnt(6)
    v_mfma_f32_32x32x16_bf16 v[32:47], v[56:59], v[60:63], v[32:47]
    ds_read_b64_tr_b16 v[56:57], v17 offset:6400
    ds_read_b64_tr_b16 v[58:59], v17 offset:6912
    ds_read_b128 v[60:63], v18 offset:7168
    s_waitcnt lgkmcnt(6)
    v_mfma_f32_32x32x16_bf16 v[32:47], v[64:67], v[68:71], v[32:47]
    ds_read_b64_tr_b16 v[64:65], v17 offset:7168
    ds_read_b64_tr_b16 v[66:67], v17 offset:7680
    ds_read_b128 v[68:71], v18 offset:8192
    s_waitcnt lgkmcnt(6)
    v_mfma_f32_32x32x16_bf16 v[32:47], v[48:51], v[52:55], v[32:47]
    ds_read_b64_tr_b16 v[48:49], v17 offset:8192
    ds_read_b64_tr_b16 v[50:51], v17 offset:8704
    ds_read_b128 v[52:55], v18 offset:9216
    s_waitcnt lgkmcnt(6)
    v_mfma_f32_32x32x16_bf16 v[32:47], v[56:59], v[60:63], v[32:47]
    ds_read_b64_tr_b16 v[56:57], v17 offset:8960
    ds_read_b64_tr_b16 v[58:59], v17 offset:9472
    ds_read_b128 v[60:63], v18 offset:10240
    s_waitcnt lgkmcnt(6)
    v_mfma_f32_32x32x16_bf16 v[32:47], v[64:67], v[68:71], v[32:47]
    ds_read_b64_tr_b16 v[64:65], v17 offset:9984
    ds_read_b64_tr_b16 v[66:67], v17 offset:10496
    ds_read_b128 v[68:71], v18 offset:11264
    s_waitcnt lgkmcnt(6)
    v_mfma_f32_32x32x16_bf16 v[32:47], v[48:51], v[52:55], v[32:47]
    ds_read_b64_tr_b16 v[48:49], v17 offset:10752
    ds_read_b64_tr_b16 v[50:51], v17 offset:11264
    ds_read_b128 v[52:55], v18 offset:12288
    s_waitcnt lgkmcnt(6)
    v_mfma_f32_32x32x16_bf16 v[32:47], v[56:59], v[60:63], v[32:47]
    ds_read_b64_tr_b16 v[56:57], v17 offset:11776
    ds_read_b64_tr_b16 v[58:59], v17 offset:12288
    ds_read_b128 v[60:63], v18 offset:13312
    s_waitcnt lgkmcnt(6)
    v_mfma_f32_32x32x16_bf16 v[32:47], v[64:67], v[68:71], v[32:47]
    ds_read_b64_tr_b16 v[64:65], v17 offset:12544
    ds_read_b64_tr_b16 v[66:67], v17 offset:13056
    ds_read_b128 v[68:71], v18 offset:14336
    s_waitcnt lgkmcnt(6)
    v_mfma_f32_32x32x16_bf16 v[32:47], v[48:51], v[52:55], v[32:47]
    ds_read_b64_tr_b16 v[48:49], v17 offset:13568
    ds_read_b64_tr_b16 v[50:51], v17 offset:14080
    ds_read_b128 v[52:55], v18 offset:15360
    s_waitcnt lgkmcnt(6)
    v_mfma_f32_32x32x16_bf16 v[32:47], v[56:59], v[60:63], v[32:47]
    s_waitcnt vmcnt(0)
    s_barrier
    ds_read_b64_tr_b16 v[56:57], v17 offset:14336
    ds_read_b64_tr_b16 v[58:59], v17 offset:14848
    ds_read_b128 v[60:63], v18 offset:16384
    s_waitcnt lgkmcnt(6)
    v_mfma_f32_32x32x16_bf16 v[32:47], v[64:67], v[68:71], v[32:47]
    ds_read_b64_tr_b16 v[64:65], v17 offset:15360
    ds_read_b64_tr_b16 v[66:67], v17 offset:15872
    ds_read_b128 v[68:71], v18 offset:17408
    s_waitcnt lgkmcnt(6)
    v_mfma_f32_32x32x16_bf16 v[32:47], v[48:51], v[52:55], v[32:47]
    ds_read_b64_tr_b16 v[48:49], v17 offset:16128
    ds_read_b64_tr_b16 v[50:51], v17 offset:16640
    ds_read_b128 v[52:55], v18 offset:18432
    s_waitcnt lgkmcnt(6)
    v_mfma_f32_32x32x16_bf16 v[32:47], v[56:59], v[60:63], v[32:47]
    ds_read_b64_tr_b16 v[56:57], v17 offset:17152
    ds_read_b64_tr_b16 v[58:59], v17 offset:17664
    ds_read_b128 v[60:63], v18 offset:19456
    s_waitcnt lgkmcnt(6)
    v_mfma_f32_32x32x16_bf16 v[32:47], v[64:67], v[68:71], v[32:47]
    ds_read_b64_tr_b16 v[64:65], v17 offset:17920
    ds_read_b64_tr_b16 v[66:67], v17 offset:18432
    ds_read_b128 v[68:71], v18 offset:20480
    s_waitcnt lgkmcnt(6)
    v_mfma_f32_32x32x16_bf16 v[32:47], v[48:51], v[52:55], v[32:47]
    ds_read_b64_tr_b16 v[48:49], v17 offset:18944
    ds_read_b64_tr_b16 v[50:51], v17 offset:19456
    ds_read_b128 v[52:55], v18 offset:21504
    s_waitcnt lgkmcnt(6)
    v_mfma_f32_32x32x16_bf16 v[32:47], v[56:59], v[60:63], v[32:47]
    ds_read_b64_tr_b16 v[56:57], v17 offset:19712
    ds_read_b64_tr_b16 v[58:59], v17 offset:20224
    ds_read_b128 v[60:63], v18 offset:22528
    s_waitcnt lgkmcnt(6)
    v_mfma_f32_32x32x16_bf16 v[32:47], v[64:67], v[68:71], v[32:47]
    ds_read_b64_tr_b16 v[64:65], v17 offset:20736
    ds_read_b64_tr_b16 v[66:67], v17 offset:21248
    ds_read_b128 v[68:71], v18 offset:23552
    s_waitcnt lgkmcnt(6)
    v_mfma_f32_32x32x16_bf16 v[32:47], v[48:51], v[52:55], v[32:47]
    ds_read_b64_tr_b16 v[48:49], v17 offset:21504
    ds_read_b64_tr_b16 v[50:51], v17 offset:22016
    ds_read_b128 v[52:55], v18 offset:24576
    s_waitcnt lgkmcnt(6)
    v_mfma_f32_32x32x16_bf16 v[32:47], v[56:59], v[60:63], v[32:47]
    ds_read_b64_tr_b16 v[56:57], v17 offset:22528
    ds_read_b64_tr_b16 v[58:59], v17 offset:23040
    ds_read_b128 v[60:63], v18 offset:25600
    s_waitcnt lgkmcnt(6)
    v_mfma_f32_32x32x16_bf16 v[32:47], v[64:67], v[68:71], v[32:47]
    ds_read_b64_tr_b16 v[64:65], v17 offset:23296
    ds_read_b64_tr_b16 v[66:67], v17 offset:23808
    ds_read_b128 v[68:71], v18 offset:26624
    s_waitcnt lgkmcnt(6)
    v_mfma_f32_32x32x16_bf16 v[32:47], v[48:51], v[52:55], v[32:47]
    ds_read_b64_tr_b16 v[48:49], v17 offset:24320
    ds_read_b64_tr_b16 v[50:51], v17 offset:24832
    ds_read_b128 v[52:55], v18 offset:27648
    s_waitcnt lgkmcnt(6)
    v_mfma_f32_32x32x16_bf16 v[32:47], v[56:59], v[60:63], v[32:47]
    ds_read_b64_tr_b16 v[56:57], v17 offset:25088
    ds_read_b64_tr_b16 v[58:59], v17 offset:25600
    ds_read_b128 v[60:63], v18 offset:28672
    s_waitcnt lgkmcnt(6)
    v_mfma_f32_32x32x16_bf16 v[32:47], v[64:67], v[68:71], v[32:47]
    ds_read_b64_tr_b16 v[64:65], v17 offset:26112
    ds_read_b64_tr_b16 v[66:67], v17 offset:26624
    ds_read_b128 v[68:71], v18 offset:29696
    s_waitcnt lgkmcnt(6)
    v_mfma_f32_32x32x16_bf16 v[32:47], v[48:51], v[52:55], v[32:47]
    ds_read_b64_tr_b16 v[48:49], v17 offset:26880
    ds_read_b64_tr_b16 v[50:51], v17 offset:27392
    ds_read_b128 v[52:55], v18 offset:30720
    s_waitcnt lgkmcnt(6)
    v_mfma_f32_32x32x16_bf16 v[32:47], v[56:59], v[60:63], v[32:47]
    ds_read_b64_tr_b16 v[56:57], v17 offset:27904
    ds_read_b64_tr_b16 v[58:59], v17 offset:28416
    ds_read_b128 v[60:63], v18 offset:31744
    s_waitcnt lgkmcnt(6)
    v_mfma_f32_32x32x16_bf16 v[32:47], v[64:67], v[68:71], v[32:47]
    ds_read_b64 v[72:73], v22
    ds_read_b64_tr_b16 v[80:81], v19 offset:0
    ds_read_b64 v[74:75], v23
    ds_read_b64_tr_b16 v[82:83], v19 offset:1024
    s_waitcnt lgkmcnt(7)
    v_mfma_f32_32x32x16_bf16 v[32:47], v[48:51], v[52:55], v[32:47]
    ds_read_b64 v[76:77], v24
    ds_read_b64_tr_b16 v[84:85], v19 offset:2048
    ds_read_b64 v[78:79], v25
    ds_read_b64_tr_b16 v[86:87], v19 offset:3072
    s_waitcnt lgkmcnt(8)
    v_mfma_f32_32x32x16_bf16 v[32:47], v[56:59], v[60:63], v[32:47]
    v_sub_f32 v13, 1.0, v12
    s_waitcnt lgkmcnt(0)
    v_lshlrev_b32 v96, 16, v72
    v_and_b32 v97, 0xffff0000, v72
    v_lshlrev_b32 v98, 16, v80
    v_and_b32 v99, 0xffff0000, v80
    v_mul_f32 v96, v96, v98
    v_mul_f32 v97, v97, v99
    v_mul_f32 v104, v13, v96
    v_mul_f32 v105, v13, v97
    v_lshlrev_b32 v96, 16, v73
    v_and_b32 v97, 0xffff0000, v73
    v_lshlrev_b32 v98, 16, v81
    v_and_b32 v99, 0xffff0000, v81
    v_mul_f32 v96, v96, v98
    v_mul_f32 v97, v97, v99
    v_mul_f32 v106, v13, v96
    v_mul_f32 v107, v13, v97
    v_lshlrev_b32 v96, 16, v74
    v_and_b32 v97, 0xffff0000, v74
    v_lshlrev_b32 v98, 16, v82
    v_and_b32 v99, 0xffff0000, v82
    v_mul_f32 v96, v96, v98
    v_mul_f32 v97, v97, v99
    v_mul_f32 v108, v13, v96
    v_mul_f32 v109, v13, v97
    v_lshlrev_b32 v96, 16, v75
    v_and_b32 v97, 0xffff0000, v75
    v_lshlrev_b32 v98, 16, v83
    v_and_b32 v99, 0xffff0000, v83
    v_mul_f32 v96, v96, v98
    v_mul_f32 v97, v97, v99
    v_mul_f32 v110, v13, v96
    v_mul_f32 v111, v13, v97
    v_lshlrev_b32 v96, 16, v76
    v_and_b32 v97, 0xffff0000, v76
    v_lshlrev_b32 v98, 16, v84
    v_and_b32 v99, 0xffff0000, v84
    v_mul_f32 v96, v96, v98
    v_mul_f32 v97, v97, v99
    v_mul_f32 v112, v13, v96
    v_mul_f32 v113, v13, v97
    v_lshlrev_b32 v96, 16, v77
    v_and_b32 v97, 0xffff0000, v77
    v_lshlrev_b32 v98, 16, v85
    v_and_b32 v99, 0xffff0000, v85
    v_mul_f32 v96, v96, v98
    v_mul_f32 v97, v97, v99
    v_mul_f32 v114, v13, v96
    v_mul_f32 v115, v13, v97
    v_lshlrev_b32 v96, 16, v78
    v_and_b32 v97, 0xffff0000, v78
    v_lshlrev_b32 v98, 16, v86
    v_and_b32 v99, 0xffff0000, v86
    v_mul_f32 v96, v96, v98
    v_mul_f32 v97, v97, v99
    v_mul_f32 v116, v13, v96
    v_mul_f32 v117, v13, v97
    v_lshlrev_b32 v96, 16, v79
    v_and_b32 v97, 0xffff0000, v79
    v_lshlrev_b32 v98, 16, v87
    v_and_b32 v99, 0xffff0000, v87
    v_mul_f32 v96, v96, v98
    v_mul_f32 v97, v97, v99
    v_mul_f32 v118, v13, v96
    v_mul_f32 v119, v13, v97
    v_fmac_f32 v104, v12, v32
    v_fmac_f32 v105, v12, v33
    v_fmac_f32 v106, v12, v34
    v_fmac_f32 v107, v12, v35
    v_fmac_f32 v108, v12, v36
    v_fmac_f32 v109, v12, v37
    v_fmac_f32 v110, v12, v38
    v_fmac_f32 v111, v12, v39
    v_fmac_f32 v112, v12, v40
    v_fmac_f32 v113, v12, v41
    v_fmac_f32 v114, v12, v42
    v_fmac_f32 v115, v12, v43
    v_fmac_f32 v116, v12, v44
    v_fmac_f32 v117, v12, v45
    v_fmac_f32 v118, v12, v46
    v_fmac_f32 v119, v12, v47
    v_cvt_pk_bf16_f32 v88, v104, v105
    v_cvt_pk_bf16_f32 v89, v106, v107
    v_cvt_pk_bf16_f32 v90, v108, v109
    v_cvt_pk_bf16_f32 v91, v110, v111
    v_cvt_pk_bf16_f32 v92, v112, v113
    v_cvt_pk_bf16_f32 v93, v114, v115
    v_cvt_pk_bf16_f32 v94, v116, v117
    v_cvt_pk_bf16_f32 v95, v118, v119
    v_permlane32_swap_b32 v88, v90
    v_permlane32_swap_b32 v89, v91
    buffer_store_dwordx4 v[88:91], v26, s[36:39], 0 offen offset:0
    v_permlane32_swap_b32 v92, v94
    v_permlane32_swap_b32 v93, v95
    buffer_store_dwordx4 v[92:95], v26, s[36:39], 0 offen offset:32
    s_branch L_fin_74
L_tailB_73:
    s_barrier
    s_barrier
    s_cmp_eq_u32 s66, 0
    s_cbranch_scc1 L_fin_74
    s_cmp_lg_u32 s3, 4
    s_cbranch_scc1 L_nopoll_76
    s_lshr_b32 s59, s64, 1
    s_lshl_b32 s59, s59, 4
    s_lshl_b32 s59, s59, 7
    s_add_u32 s59, s59, 6586368
    v_lshlrev_b32 v250, 7, v1
    v_add_u32 v250, s59, v250
    s_mov_b32 s74, 0
    s_mov_b64 exec, 0xffff
L_pollm_77:
    buffer_load_dword v251, v250, s[4:7], 0 offen sc1
    s_waitcnt vmcnt(0)
    v_cmp_gt_u32 vcc, 1, v251
    s_add_u32 s74, s74, 1
    s_nop 2
    s_cmp_eq_u64 vcc, 0
    s_cbranch_scc1 L_pollmx_78
    s_cmp_ge_u32 s74, 65536
    s_cbranch_scc1 L_pollmx_78
    s_sleep 2
    s_branch L_pollm_77
L_pollmx_78:
    s_mov_b64 exec, -1
L_nopoll_76:
    s_barrier
    s_lshl_b32 s56, s64, 8
    s_add_u32 s56, s56, 6356992
    v_lshlrev_b32 v3, 2, v1
    s_mov_b32 m0, 29184
    s_nop 0
    buffer_load_dword v3, s[4:7], s56 offen sc1 lds
    s_lshr_b32 s56, s3, 2
    s_lshl_b32 s56, s56, 15
    s_and_b32 s57, s3, 3
    s_lshl_b32 s57, s57, 12
    s_add_u32 s57, s57, s56
    s_lshl_b32 s56, s64, 16
    s_add_u32 s56, s56, s57
    s_add_u32 s56, s56, 11534336
    v_lshlrev_b32 v2, 4, v1
    s_add_u32 m0, s57, 65536
    s_add_u32 s58, s56, 0
    buffer_load_dwordx4 v2, s[4:7], s58 offen offset:0 sc1 lds
    buffer_load_dwordx4 v2, s[4:7], s58 offen offset:1024 sc1 lds
    buffer_load_dwordx4 v2, s[4:7], s58 offen offset:2048 sc1 lds
    buffer_load_dwordx4 v2, s[4:7], s58 offen offset:3072 sc1 lds
    s_add_u32 m0, s57, 81920
    s_add_u32 s58, s56, 16384
    buffer_load_dwordx4 v2, s[4:7], s58 offen offset:0 sc1 lds
    buffer_load_dwordx4 v2, s[4:7], s58 offen offset:1024 sc1 lds
    buffer_load_dwordx4 v2, s[4:7], s58 offen offset:2048 sc1 lds
    buffer_load_dwordx4 v2, s[4:7], s58 offen offset:3072 sc1 lds
    s_waitcnt vmcnt(4)
    s_barrier
    s_waitcnt vmcnt(0)
    s_barrier
L_fin_74:
L_end_1:
    s_endpgm
L_code_end:
    s_endpgm
.section .rodata,"a"
.p2align 6
.amdhsa_kernel gated_mix__softmax_full_mha__ssm_conv_h3__prompt_kernel
  .amdhsa_next_free_vgpr 256
  .amdhsa_next_free_sgpr 102
  .amdhsa_accum_offset 256
  .amdhsa_group_segment_fixed_size 0
  .amdhsa_kernarg_size 104
  .amdhsa_user_sgpr_count 2
  .amdhsa_user_sgpr_kernarg_segment_ptr 1
  .amdhsa_system_sgpr_workgroup_id_x 1
.end_amdhsa_kernel
```
